```python
import torch

def _softmax(x, axis=-1):
    return torch.softmax(x, dim=axis)
def _gelu(x):
    return torch.nn.functional.gelu(x, approximate="tanh")
def _silu(x):
    return torch.nn.functional.silu(x)
def _sigmoid(x):
    return torch.sigmoid(x)
def _layernorm(x, axis=-1, eps=1e-5):
    m = x.mean(dim=axis, keepdim=True)
    v = x.var(dim=axis, keepdim=True, unbiased=False)
    return (x - m) / torch.sqrt(v + eps)
def _scatter_add(tgt, idx, src, axis=0):
    return tgt.clone().index_add_(axis, idx, src)
def _segment_sum(src, seg, n):
    out = torch.zeros((n,) + src.shape[1:], dtype=src.dtype)
    return out.index_add_(0, seg, src)
def _pad(x, pw):
    flat = tuple(v for pair in reversed(pw) for v in pair)
    return torch.nn.functional.pad(x, flat)

kernel_name = 'recurrent_scan__mha_block_cached__swiglu_ffn__decode'

def setup_inputs():

    _w = (lambda a: (lambda t: t.to(torch.bfloat16) if t.is_floating_point() else t)(torch.as_tensor(a)))
    def _A_setup():
        B, Sq, D = 2, 1, 640
        H, Sk, Dh = 32, 16384, 192
        return {
            "x": _w((lambda *s: torch.randn(*s, dtype=torch.bfloat16) * 0.05)(B, Sq, D)),
            "k_cache": _w((lambda *s: torch.randn(*s, dtype=torch.bfloat16) * 1.6)(B, H, Sk, Dh)),
            "v_cache": _w((lambda *s: torch.randn(*s, dtype=torch.bfloat16) * 0.2)(B, H, Sk, Dh)),
            "wq": _w((lambda *s: torch.randn(*s, dtype=torch.bfloat16) * 1.6)(D, H * Dh) * (D ** -0.5)),
            "wo": _w((lambda *s: torch.randn(*s, dtype=torch.bfloat16) * 0.2)(H * Dh, D) * ((H * Dh) ** -0.5)),
        }
    _A_in = _A_setup()

    def _B_setup():
        B, S, D, F = 2, 1, 640, 1536
        return {
            "x": _w((lambda *s: torch.randn(*s, dtype=torch.bfloat16) * 0.05)(B, S, D)),
            "w_gate": _w((lambda *s: torch.randn(*s, dtype=torch.bfloat16) * 0.1)(D, F)),
            "w_up": _w((lambda *s: torch.randn(*s, dtype=torch.bfloat16) * 0.1)(D, F)),
            "w_down": _w((lambda *s: torch.randn(*s, dtype=torch.bfloat16) * 0.1)(F, D)),
        }
    _B_in = _B_setup()

    return {
        "A_x": _A_in["x"],
        "A_k_cache": _A_in["k_cache"],
        "A_v_cache": _A_in["v_cache"],
        "A_wq": _A_in["wq"],
        "A_wo": _A_in["wo"],
        "B_x": _B_in["x"],
        "B_w_gate": _B_in["w_gate"],
        "B_w_up": _B_in["w_up"],
        "B_w_down": _B_in["w_down"],
    }

def reference(A_x, A_k_cache, A_v_cache, A_wq, A_wo, B_x, B_w_gate, B_w_up, B_w_down):
    def _A_ref(x, k_cache, v_cache, wq, wo):
        B, Sq, D = x.shape
        H, Dh = 32, 192
        q = (lambda x, *d: x.permute(*d))((x @ wq).reshape(B, Sq, H, Dh), 0, 2, 1, 3)
        scores = torch.einsum("bhqd,bhkd->bhqk", q, k_cache) * (Dh ** -0.5)
        p = _softmax(scores, axis=-1)
        o = torch.einsum("bhqk,bhkd->bhqd", p, v_cache)
        return (lambda x, *d: x.permute(*d))(o, 0, 2, 1, 3).reshape(B, Sq, H * Dh) @ wo

    def _B_ref(x, w_gate, w_up, w_down):
        g = _silu(x @ w_gate)
        u = x @ w_up
        return (g * u) @ w_down

    x = A_x
    xn = _layernorm(x, axis=-1)
    s = _A_ref(xn, A_k_cache, A_v_cache, A_wq, A_wo)
    g = _silu(_B_ref(xn, B_w_gate, B_w_up, B_w_down))
    return x + s * g
```

```asm
; @launch grid=(256,1,1) block=(512,1,1) lds=20480
.amdgcn_target "amdgcn-amd-amdhsa--gfx950"
.text
.globl recurrent_scan__mha_block_cached__swiglu_ffn__decode_kernel
.p2align 8
.type recurrent_scan__mha_block_cached__swiglu_ffn__decode_kernel,@function
recurrent_scan__mha_block_cached__swiglu_ffn__decode_kernel:
  s_cmp_ge_u32 s2, 256
  s_cbranch_scc1 L_end
  s_load_dwordx16 s[4:19], s[0:1], 0
  s_load_dwordx8 s[20:27], s[0:1], 64
  v_lshrrev_b32 v1, 6, v0
  v_and_b32 v0, 63, v0
  v_readfirstlane_b32 s3, v1
  s_and_b32 s28, s2, 7
  s_mul_i32 s46, s28, 40
  s_add_u32 s46, s46, s2
  s_and_b32 s46, s46, 0xf8
  s_or_b32 s2, s46, s28
  s_lshr_b32 s29, s2, 3
  s_and_b32 s29, s29, 15
  s_lshr_b32 s32, s2, 7
  s_lshr_b32 s30, s2, 3
  s_mov_b32 s33, 0x3d93cd3a
  s_mov_b32 s34, 0x3fb8aa3b
  s_waitcnt lgkmcnt(0)
  s_or_b32 s46, s2, s3
  s_cmp_lg_u32 s46, 0
  s_cbranch_scc1 L_notag
  s_mov_b32 s52, s24
  s_mov_b32 s53, s25
  s_mov_b32 s54, 256
  s_mov_b32 s55, 0x20000
  s_memrealtime s[60:61]
  v_mov_b32 v3, 0
  s_waitcnt lgkmcnt(0)
  s_or_b32 s60, s60, 1
  s_or_b32 s61, s61, 0x80000000
  v_mov_b32 v4, s60
  v_mov_b32 v5, s61
  s_mov_b64 exec, 1
  buffer_store_dwordx2 v[4:5], v3, s[52:55], 0 offen offset:8 sc1
  s_mov_b64 exec, -1
L_notag:
  s_cmp_ge_u32 s3, 4
  s_cbranch_scc1 L_helper
  s_lshr_b32 s35, s2, 3
  s_lshl_b32 s47, s35, 8
  s_add_u32 s47, s47, 3145728
  s_mul_i32 s35, s35, 6291456
  s_add_u32 s36, s6, s35
  s_addc_u32 s37, s7, 0
  s_mov_b32 s38, 207618048
  s_mov_b32 s39, 0x20000
  s_add_u32 s40, s8, s35
  s_addc_u32 s41, s9, 0
  s_mov_b32 s42, 207618048
  s_mov_b32 s43, 0x20000
  v_lshrrev_b32 v2, 3, v0
  v_mul_u32_u24 v2, 384, v2
  v_and_b32 v3, 7, v0
  v_lshl_add_u32 v1, v3, 4, v2
  s_lshl_b32 s44, s28, 2
  s_add_u32 s44, s44, s3
  s_lshr_b32 s46, s2, 3
  s_mul_i32 s46, s46, 14
  s_and_b32 s57, s46, 1023
  s_add_u32 s44, s44, s57
  s_and_b32 s44, s44, 1023
  s_mov_b32 s56, 6291456
  s_mul_i32 s44, s44, 6144
  buffer_load_dwordx4 v[56:59], v1, s[36:39], s44 offen offset:0 nt
  buffer_load_dwordx4 v[60:63], v1, s[36:39], s44 offen offset:128 nt
  buffer_load_dwordx4 v[64:67], v1, s[36:39], s44 offen offset:256 nt
  buffer_load_dwordx4 v[68:71], v1, s[36:39], s44 offen offset:3072 nt
  buffer_load_dwordx4 v[72:75], v1, s[36:39], s44 offen offset:3200 nt
  buffer_load_dwordx4 v[76:79], v1, s[36:39], s44 offen offset:3328 nt
  s_branch L_stream_rest
L_helper:
  s_sub_u32 s35, s3, 4
  s_mov_b32 s48, s26
  s_mov_b32 s49, s27
  s_mov_b32 s50, 8388608
  s_mov_b32 s51, 0x20000
  v_lshlrev_b32 v1, 2, v0
  s_mov_b32 s52, s24
  s_mov_b32 s53, s25
  s_mov_b32 s54, 256
  s_mov_b32 s55, 0x20000
  v_mov_b32 v3, 0
  s_cmp_eq_u32 s35, 2
  s_cbranch_scc1 L_qgather
  s_cmp_eq_u32 s35, 3
  s_cbranch_scc1 L_qaux
  s_mov_b32 s36, s4
  s_mov_b32 s37, s5
  s_mov_b32 s38, 2560
  s_mov_b32 s39, 0x20000
  s_mov_b32 s40, s10
  s_mov_b32 s41, s11
  s_mov_b32 s42, 7864320
  s_mov_b32 s43, 0x20000
  s_mul_i32 s46, s35, 1280
  buffer_load_dword v16, v1, s[36:39], s46 offen offset:0
  buffer_load_dword v17, v1, s[36:39], s46 offen offset:256
  buffer_load_dword v18, v1, s[36:39], s46 offen offset:512
  buffer_load_dword v19, v1, s[36:39], s46 offen offset:768
  buffer_load_dword v20, v1, s[36:39], s46 offen offset:1024
  v_lshrrev_b32 v2, 3, v0
  v_mul_u32_u24 v2, 10, v2
  s_mul_i32 s56, s28, 80
  v_add_u32 v2, s56, v2
  v_lshlrev_b32 v5, 2, v2
  s_mov_b32 s57, 12288
  v_mul_lo_u32 v2, v2, s57
  v_and_b32 v4, 7, v0
  v_lshl_add_u32 v2, v4, 4, v2
  s_mul_i32 s58, s30, 384
  buffer_load_dwordx4 v[72:75], v2, s[40:43], s58 offen offset:0
  buffer_load_dwordx4 v[76:79], v2, s[40:43], s58 offen offset:128
  buffer_load_dwordx4 v[80:83], v2, s[40:43], s58 offen offset:256
  s_add_u32 s58, s58, 12288
  buffer_load_dwordx4 v[84:87], v2, s[40:43], s58 offen offset:0
  buffer_load_dwordx4 v[88:91], v2, s[40:43], s58 offen offset:128
  buffer_load_dwordx4 v[92:95], v2, s[40:43], s58 offen offset:256
  s_add_u32 s58, s58, 12288
  buffer_load_dwordx4 v[96:99], v2, s[40:43], s58 offen offset:0
  buffer_load_dwordx4 v[100:103], v2, s[40:43], s58 offen offset:128
  buffer_load_dwordx4 v[104:107], v2, s[40:43], s58 offen offset:256
  s_add_u32 s58, s58, 12288
  buffer_load_dwordx4 v[108:111], v2, s[40:43], s58 offen offset:0
  buffer_load_dwordx4 v[112:115], v2, s[40:43], s58 offen offset:128
  buffer_load_dwordx4 v[116:119], v2, s[40:43], s58 offen offset:256
  s_add_u32 s58, s58, 12288
  buffer_load_dwordx4 v[120:123], v2, s[40:43], s58 offen offset:0
  buffer_load_dwordx4 v[124:127], v2, s[40:43], s58 offen offset:128
  buffer_load_dwordx4 v[128:131], v2, s[40:43], s58 offen offset:256
  s_add_u32 s58, s58, 12288
  buffer_load_dwordx4 v[132:135], v2, s[40:43], s58 offen offset:0
  buffer_load_dwordx4 v[136:139], v2, s[40:43], s58 offen offset:128
  buffer_load_dwordx4 v[140:143], v2, s[40:43], s58 offen offset:256
  s_add_u32 s58, s58, 12288
  buffer_load_dwordx4 v[144:147], v2, s[40:43], s58 offen offset:0
  buffer_load_dwordx4 v[148:151], v2, s[40:43], s58 offen offset:128
  buffer_load_dwordx4 v[152:155], v2, s[40:43], s58 offen offset:256
  s_add_u32 s58, s58, 12288
  buffer_load_dwordx4 v[156:159], v2, s[40:43], s58 offen offset:0
  buffer_load_dwordx4 v[160:163], v2, s[40:43], s58 offen offset:128
  buffer_load_dwordx4 v[164:167], v2, s[40:43], s58 offen offset:256
  s_add_u32 s58, s58, 12288
  buffer_load_dwordx4 v[168:171], v2, s[40:43], s58 offen offset:0
  buffer_load_dwordx4 v[172:175], v2, s[40:43], s58 offen offset:128
  buffer_load_dwordx4 v[176:179], v2, s[40:43], s58 offen offset:256
  s_add_u32 s58, s58, 12288
  buffer_load_dwordx4 v[180:183], v2, s[40:43], s58 offen offset:0
  buffer_load_dwordx4 v[184:187], v2, s[40:43], s58 offen offset:128
  buffer_load_dwordx4 v[188:191], v2, s[40:43], s58 offen offset:256
  s_add_u32 s58, s58, 12288
  s_mul_i32 s59, s35, 2560
  s_waitcnt vmcnt(30)
  v_lshlrev_b32 v6, 16, v16
  v_and_b32 v7, 0xffff0000, v16
  v_lshlrev_b32 v8, 16, v17
  v_and_b32 v9, 0xffff0000, v17
  v_lshlrev_b32 v10, 16, v18
  v_and_b32 v11, 0xffff0000, v18
  v_lshlrev_b32 v12, 16, v19
  v_and_b32 v13, 0xffff0000, v19
  v_lshlrev_b32 v14, 16, v20
  v_and_b32 v15, 0xffff0000, v20
  v_add_f32 v240, v6, v7
  v_add_f32 v240, v240, v8
  v_add_f32 v240, v240, v9
  v_add_f32 v240, v240, v10
  v_add_f32 v240, v240, v11
  v_add_f32 v240, v240, v12
  v_add_f32 v240, v240, v13
  v_add_f32 v240, v240, v14
  v_add_f32 v240, v240, v15
  s_nop 1
  v_add_f32_dpp v240, v240, v240 row_ror:8 row_mask:0xf bank_mask:0xf
  s_nop 1
  v_add_f32_dpp v240, v240, v240 row_ror:4 row_mask:0xf bank_mask:0xf
  s_nop 1
  v_add_f32_dpp v240, v240, v240 row_ror:2 row_mask:0xf bank_mask:0xf
  s_nop 1
  v_add_f32_dpp v240, v240, v240 row_ror:1 row_mask:0xf bank_mask:0xf
  v_mov_b32 v241, v240
  s_nop 1
  v_permlane16_swap_b32 v240, v241
  v_add_f32 v240, v240, v241
  v_mov_b32 v241, v240
  s_nop 1
  v_permlane32_swap_b32 v240, v241
  v_add_f32 v240, v240, v241
  v_mul_f32 v240, 0x3acccccd, v240
  v_cvt_pk_bf16_f32 v242, v240, v240
  v_and_b32 v242, 0xffff0000, v242
  v_sub_f32 v244, v6, v240
  v_mul_f32 v243, v244, v244
  v_sub_f32 v244, v7, v240
  v_fmac_f32 v243, v244, v244
  v_sub_f32 v244, v8, v240
  v_fmac_f32 v243, v244, v244
  v_sub_f32 v244, v9, v240
  v_fmac_f32 v243, v244, v244
  v_sub_f32 v244, v10, v240
  v_fmac_f32 v243, v244, v244
  v_sub_f32 v244, v11, v240
  v_fmac_f32 v243, v244, v244
  v_sub_f32 v244, v12, v240
  v_fmac_f32 v243, v244, v244
  v_sub_f32 v244, v13, v240
  v_fmac_f32 v243, v244, v244
  v_sub_f32 v244, v14, v240
  v_fmac_f32 v243, v244, v244
  v_sub_f32 v244, v15, v240
  v_fmac_f32 v243, v244, v244
  s_nop 1
  v_add_f32_dpp v243, v243, v243 row_ror:8 row_mask:0xf bank_mask:0xf
  s_nop 1
  v_add_f32_dpp v243, v243, v243 row_ror:4 row_mask:0xf bank_mask:0xf
  s_nop 1
  v_add_f32_dpp v243, v243, v243 row_ror:2 row_mask:0xf bank_mask:0xf
  s_nop 1
  v_add_f32_dpp v243, v243, v243 row_ror:1 row_mask:0xf bank_mask:0xf
  v_mov_b32 v241, v243
  s_nop 1
  v_permlane16_swap_b32 v243, v241
  v_add_f32 v243, v243, v241
  v_mov_b32 v241, v243
  s_nop 1
  v_permlane32_swap_b32 v243, v241
  v_add_f32 v243, v243, v241
  v_mul_f32 v243, 0x3acccccd, v243
  v_cvt_pk_bf16_f32 v243, v243, v243
  v_and_b32 v243, 0xffff0000, v243
  v_add_f32 v243, 0x3727c5ac, v243
  v_cvt_pk_bf16_f32 v243, v243, v243
  v_and_b32 v243, 0xffff0000, v243
  v_sqrt_f32 v243, v243
  s_nop 0
  v_cvt_pk_bf16_f32 v243, v243, v243
  v_and_b32 v243, 0xffff0000, v243
  v_rcp_f32 v243, v243
  v_sub_f32 v6, v6, v242
  v_cvt_pk_bf16_f32 v6, v6, v6
  v_and_b32 v6, 0xffff0000, v6
  v_mul_f32 v6, v6, v243
  v_cvt_pk_bf16_f32 v6, v6, v6
  v_and_b32 v6, 0xffff0000, v6
  v_sub_f32 v7, v7, v242
  v_cvt_pk_bf16_f32 v7, v7, v7
  v_and_b32 v7, 0xffff0000, v7
  v_mul_f32 v7, v7, v243
  v_cvt_pk_bf16_f32 v7, v7, v7
  v_and_b32 v7, 0xffff0000, v7
  v_sub_f32 v8, v8, v242
  v_cvt_pk_bf16_f32 v8, v8, v8
  v_and_b32 v8, 0xffff0000, v8
  v_mul_f32 v8, v8, v243
  v_cvt_pk_bf16_f32 v8, v8, v8
  v_and_b32 v8, 0xffff0000, v8
  v_sub_f32 v9, v9, v242
  v_cvt_pk_bf16_f32 v9, v9, v9
  v_and_b32 v9, 0xffff0000, v9
  v_mul_f32 v9, v9, v243
  v_cvt_pk_bf16_f32 v9, v9, v9
  v_and_b32 v9, 0xffff0000, v9
  v_sub_f32 v10, v10, v242
  v_cvt_pk_bf16_f32 v10, v10, v10
  v_and_b32 v10, 0xffff0000, v10
  v_mul_f32 v10, v10, v243
  v_cvt_pk_bf16_f32 v10, v10, v10
  v_and_b32 v10, 0xffff0000, v10
  v_sub_f32 v11, v11, v242
  v_cvt_pk_bf16_f32 v11, v11, v11
  v_and_b32 v11, 0xffff0000, v11
  v_mul_f32 v11, v11, v243
  v_cvt_pk_bf16_f32 v11, v11, v11
  v_and_b32 v11, 0xffff0000, v11
  v_sub_f32 v12, v12, v242
  v_cvt_pk_bf16_f32 v12, v12, v12
  v_and_b32 v12, 0xffff0000, v12
  v_mul_f32 v12, v12, v243
  v_cvt_pk_bf16_f32 v12, v12, v12
  v_and_b32 v12, 0xffff0000, v12
  v_sub_f32 v13, v13, v242
  v_cvt_pk_bf16_f32 v13, v13, v13
  v_and_b32 v13, 0xffff0000, v13
  v_mul_f32 v13, v13, v243
  v_cvt_pk_bf16_f32 v13, v13, v13
  v_and_b32 v13, 0xffff0000, v13
  v_sub_f32 v14, v14, v242
  v_cvt_pk_bf16_f32 v14, v14, v14
  v_and_b32 v14, 0xffff0000, v14
  v_mul_f32 v14, v14, v243
  v_cvt_pk_bf16_f32 v14, v14, v14
  v_and_b32 v14, 0xffff0000, v14
  v_sub_f32 v15, v15, v242
  v_cvt_pk_bf16_f32 v15, v15, v15
  v_and_b32 v15, 0xffff0000, v15
  v_mul_f32 v15, v15, v243
  v_cvt_pk_bf16_f32 v15, v15, v15
  v_and_b32 v15, 0xffff0000, v15
  v_lshlrev_b32 v244, 3, v0
  v_add_u32 v244, s59, v244
  ds_write_b64 v244, v[6:7] offset:0
  ds_write_b64 v244, v[8:9] offset:512
  ds_write_b64 v244, v[10:11] offset:1024
  ds_write_b64 v244, v[12:13] offset:1536
  ds_write_b64 v244, v[14:15] offset:2048
  v_add_u32 v5, s59, v5
  s_waitcnt lgkmcnt(0)
  ds_read_b64 v[28:29], v5 offset:0
  ds_read_b64 v[30:31], v5 offset:8
  ds_read_b64 v[32:33], v5 offset:16
  ds_read_b64 v[34:35], v5 offset:24
  ds_read_b64 v[36:37], v5 offset:32
  v_mov_b32 v48, 0
  v_mov_b32 v49, 0
  v_mov_b32 v50, 0
  v_mov_b32 v51, 0
  v_mov_b32 v52, 0
  v_mov_b32 v53, 0
  v_mov_b32 v54, 0
  v_mov_b32 v55, 0
  v_mov_b32 v56, 0
  v_mov_b32 v57, 0
  v_mov_b32 v58, 0
  v_mov_b32 v59, 0
  v_mov_b32 v60, 0
  v_mov_b32 v61, 0
  v_mov_b32 v62, 0
  v_mov_b32 v63, 0
  v_mov_b32 v64, 0
  v_mov_b32 v65, 0
  v_mov_b32 v66, 0
  v_mov_b32 v67, 0
  v_mov_b32 v68, 0
  v_mov_b32 v69, 0
  v_mov_b32 v70, 0
  v_mov_b32 v71, 0
  buffer_load_dwordx2 v[250:251], v3, s[52:55], 0 offen offset:8 sc1
  s_waitcnt lgkmcnt(0)
  s_waitcnt vmcnt(28)
  v_lshrrev_b32 v4, 16, v28
  v_dot2c_f32_bf16 v48, v72, v4
  v_dot2c_f32_bf16 v49, v72, v28
  v_dot2c_f32_bf16 v50, v73, v4
  v_dot2c_f32_bf16 v51, v73, v28
  v_dot2c_f32_bf16 v52, v74, v4
  v_dot2c_f32_bf16 v53, v74, v28
  v_dot2c_f32_bf16 v54, v75, v4
  v_dot2c_f32_bf16 v55, v75, v28
  v_dot2c_f32_bf16 v56, v76, v4
  v_dot2c_f32_bf16 v57, v76, v28
  v_dot2c_f32_bf16 v58, v77, v4
  v_dot2c_f32_bf16 v59, v77, v28
  v_dot2c_f32_bf16 v60, v78, v4
  v_dot2c_f32_bf16 v61, v78, v28
  v_dot2c_f32_bf16 v62, v79, v4
  v_dot2c_f32_bf16 v63, v79, v28
  v_dot2c_f32_bf16 v64, v80, v4
  v_dot2c_f32_bf16 v65, v80, v28
  v_dot2c_f32_bf16 v66, v81, v4
  v_dot2c_f32_bf16 v67, v81, v28
  v_dot2c_f32_bf16 v68, v82, v4
  v_dot2c_f32_bf16 v69, v82, v28
  v_dot2c_f32_bf16 v70, v83, v4
  v_dot2c_f32_bf16 v71, v83, v28
  s_waitcnt vmcnt(25)
  v_lshrrev_b32 v4, 16, v29
  v_dot2c_f32_bf16 v48, v84, v4
  v_dot2c_f32_bf16 v49, v84, v29
  v_dot2c_f32_bf16 v50, v85, v4
  v_dot2c_f32_bf16 v51, v85, v29
  v_dot2c_f32_bf16 v52, v86, v4
  v_dot2c_f32_bf16 v53, v86, v29
  v_dot2c_f32_bf16 v54, v87, v4
  v_dot2c_f32_bf16 v55, v87, v29
  v_dot2c_f32_bf16 v56, v88, v4
  v_dot2c_f32_bf16 v57, v88, v29
  v_dot2c_f32_bf16 v58, v89, v4
  v_dot2c_f32_bf16 v59, v89, v29
  v_dot2c_f32_bf16 v60, v90, v4
  v_dot2c_f32_bf16 v61, v90, v29
  v_dot2c_f32_bf16 v62, v91, v4
  v_dot2c_f32_bf16 v63, v91, v29
  v_dot2c_f32_bf16 v64, v92, v4
  v_dot2c_f32_bf16 v65, v92, v29
  v_dot2c_f32_bf16 v66, v93, v4
  v_dot2c_f32_bf16 v67, v93, v29
  v_dot2c_f32_bf16 v68, v94, v4
  v_dot2c_f32_bf16 v69, v94, v29
  v_dot2c_f32_bf16 v70, v95, v4
  v_dot2c_f32_bf16 v71, v95, v29
  s_waitcnt vmcnt(22)
  v_lshrrev_b32 v4, 16, v30
  v_dot2c_f32_bf16 v48, v96, v4
  v_dot2c_f32_bf16 v49, v96, v30
  v_dot2c_f32_bf16 v50, v97, v4
  v_dot2c_f32_bf16 v51, v97, v30
  v_dot2c_f32_bf16 v52, v98, v4
  v_dot2c_f32_bf16 v53, v98, v30
  v_dot2c_f32_bf16 v54, v99, v4
  v_dot2c_f32_bf16 v55, v99, v30
  v_dot2c_f32_bf16 v56, v100, v4
  v_dot2c_f32_bf16 v57, v100, v30
  v_dot2c_f32_bf16 v58, v101, v4
  v_dot2c_f32_bf16 v59, v101, v30
  v_dot2c_f32_bf16 v60, v102, v4
  v_dot2c_f32_bf16 v61, v102, v30
  v_dot2c_f32_bf16 v62, v103, v4
  v_dot2c_f32_bf16 v63, v103, v30
  v_dot2c_f32_bf16 v64, v104, v4
  v_dot2c_f32_bf16 v65, v104, v30
  v_dot2c_f32_bf16 v66, v105, v4
  v_dot2c_f32_bf16 v67, v105, v30
  v_dot2c_f32_bf16 v68, v106, v4
  v_dot2c_f32_bf16 v69, v106, v30
  v_dot2c_f32_bf16 v70, v107, v4
  v_dot2c_f32_bf16 v71, v107, v30
  s_waitcnt vmcnt(19)
  v_lshrrev_b32 v4, 16, v31
  v_dot2c_f32_bf16 v48, v108, v4
  v_dot2c_f32_bf16 v49, v108, v31
  v_dot2c_f32_bf16 v50, v109, v4
  v_dot2c_f32_bf16 v51, v109, v31
  v_dot2c_f32_bf16 v52, v110, v4
  v_dot2c_f32_bf16 v53, v110, v31
  v_dot2c_f32_bf16 v54, v111, v4
  v_dot2c_f32_bf16 v55, v111, v31
  v_dot2c_f32_bf16 v56, v112, v4
  v_dot2c_f32_bf16 v57, v112, v31
  v_dot2c_f32_bf16 v58, v113, v4
  v_dot2c_f32_bf16 v59, v113, v31
  v_dot2c_f32_bf16 v60, v114, v4
  v_dot2c_f32_bf16 v61, v114, v31
  v_dot2c_f32_bf16 v62, v115, v4
  v_dot2c_f32_bf16 v63, v115, v31
  v_dot2c_f32_bf16 v64, v116, v4
  v_dot2c_f32_bf16 v65, v116, v31
  v_dot2c_f32_bf16 v66, v117, v4
  v_dot2c_f32_bf16 v67, v117, v31
  v_dot2c_f32_bf16 v68, v118, v4
  v_dot2c_f32_bf16 v69, v118, v31
  v_dot2c_f32_bf16 v70, v119, v4
  v_dot2c_f32_bf16 v71, v119, v31
  s_waitcnt vmcnt(16)
  v_lshrrev_b32 v4, 16, v32
  v_dot2c_f32_bf16 v48, v120, v4
  v_dot2c_f32_bf16 v49, v120, v32
  v_dot2c_f32_bf16 v50, v121, v4
  v_dot2c_f32_bf16 v51, v121, v32
  v_dot2c_f32_bf16 v52, v122, v4
  v_dot2c_f32_bf16 v53, v122, v32
  v_dot2c_f32_bf16 v54, v123, v4
  v_dot2c_f32_bf16 v55, v123, v32
  v_dot2c_f32_bf16 v56, v124, v4
  v_dot2c_f32_bf16 v57, v124, v32
  v_dot2c_f32_bf16 v58, v125, v4
  v_dot2c_f32_bf16 v59, v125, v32
  v_dot2c_f32_bf16 v60, v126, v4
  v_dot2c_f32_bf16 v61, v126, v32
  v_dot2c_f32_bf16 v62, v127, v4
  v_dot2c_f32_bf16 v63, v127, v32
  v_dot2c_f32_bf16 v64, v128, v4
  v_dot2c_f32_bf16 v65, v128, v32
  v_dot2c_f32_bf16 v66, v129, v4
  v_dot2c_f32_bf16 v67, v129, v32
  v_dot2c_f32_bf16 v68, v130, v4
  v_dot2c_f32_bf16 v69, v130, v32
  v_dot2c_f32_bf16 v70, v131, v4
  v_dot2c_f32_bf16 v71, v131, v32
  s_waitcnt vmcnt(13)
  v_lshrrev_b32 v4, 16, v33
  v_dot2c_f32_bf16 v48, v132, v4
  v_dot2c_f32_bf16 v49, v132, v33
  v_dot2c_f32_bf16 v50, v133, v4
  v_dot2c_f32_bf16 v51, v133, v33
  v_dot2c_f32_bf16 v52, v134, v4
  v_dot2c_f32_bf16 v53, v134, v33
  v_dot2c_f32_bf16 v54, v135, v4
  v_dot2c_f32_bf16 v55, v135, v33
  v_dot2c_f32_bf16 v56, v136, v4
  v_dot2c_f32_bf16 v57, v136, v33
  v_dot2c_f32_bf16 v58, v137, v4
  v_dot2c_f32_bf16 v59, v137, v33
  v_dot2c_f32_bf16 v60, v138, v4
  v_dot2c_f32_bf16 v61, v138, v33
  v_dot2c_f32_bf16 v62, v139, v4
  v_dot2c_f32_bf16 v63, v139, v33
  v_dot2c_f32_bf16 v64, v140, v4
  v_dot2c_f32_bf16 v65, v140, v33
  v_dot2c_f32_bf16 v66, v141, v4
  v_dot2c_f32_bf16 v67, v141, v33
  v_dot2c_f32_bf16 v68, v142, v4
  v_dot2c_f32_bf16 v69, v142, v33
  v_dot2c_f32_bf16 v70, v143, v4
  v_dot2c_f32_bf16 v71, v143, v33
  s_waitcnt vmcnt(10)
  v_lshrrev_b32 v4, 16, v34
  v_dot2c_f32_bf16 v48, v144, v4
  v_dot2c_f32_bf16 v49, v144, v34
  v_dot2c_f32_bf16 v50, v145, v4
  v_dot2c_f32_bf16 v51, v145, v34
  v_dot2c_f32_bf16 v52, v146, v4
  v_dot2c_f32_bf16 v53, v146, v34
  v_dot2c_f32_bf16 v54, v147, v4
  v_dot2c_f32_bf16 v55, v147, v34
  v_dot2c_f32_bf16 v56, v148, v4
  v_dot2c_f32_bf16 v57, v148, v34
  v_dot2c_f32_bf16 v58, v149, v4
  v_dot2c_f32_bf16 v59, v149, v34
  v_dot2c_f32_bf16 v60, v150, v4
  v_dot2c_f32_bf16 v61, v150, v34
  v_dot2c_f32_bf16 v62, v151, v4
  v_dot2c_f32_bf16 v63, v151, v34
  v_dot2c_f32_bf16 v64, v152, v4
  v_dot2c_f32_bf16 v65, v152, v34
  v_dot2c_f32_bf16 v66, v153, v4
  v_dot2c_f32_bf16 v67, v153, v34
  v_dot2c_f32_bf16 v68, v154, v4
  v_dot2c_f32_bf16 v69, v154, v34
  v_dot2c_f32_bf16 v70, v155, v4
  v_dot2c_f32_bf16 v71, v155, v34
  s_waitcnt vmcnt(7)
  v_lshrrev_b32 v4, 16, v35
  v_dot2c_f32_bf16 v48, v156, v4
  v_dot2c_f32_bf16 v49, v156, v35
  v_dot2c_f32_bf16 v50, v157, v4
  v_dot2c_f32_bf16 v51, v157, v35
  v_dot2c_f32_bf16 v52, v158, v4
  v_dot2c_f32_bf16 v53, v158, v35
  v_dot2c_f32_bf16 v54, v159, v4
  v_dot2c_f32_bf16 v55, v159, v35
  v_dot2c_f32_bf16 v56, v160, v4
  v_dot2c_f32_bf16 v57, v160, v35
  v_dot2c_f32_bf16 v58, v161, v4
  v_dot2c_f32_bf16 v59, v161, v35
  v_dot2c_f32_bf16 v60, v162, v4
  v_dot2c_f32_bf16 v61, v162, v35
  v_dot2c_f32_bf16 v62, v163, v4
  v_dot2c_f32_bf16 v63, v163, v35
  v_dot2c_f32_bf16 v64, v164, v4
  v_dot2c_f32_bf16 v65, v164, v35
  v_dot2c_f32_bf16 v66, v165, v4
  v_dot2c_f32_bf16 v67, v165, v35
  v_dot2c_f32_bf16 v68, v166, v4
  v_dot2c_f32_bf16 v69, v166, v35
  v_dot2c_f32_bf16 v70, v167, v4
  v_dot2c_f32_bf16 v71, v167, v35
  s_waitcnt vmcnt(4)
  v_lshrrev_b32 v4, 16, v36
  v_dot2c_f32_bf16 v48, v168, v4
  v_dot2c_f32_bf16 v49, v168, v36
  v_dot2c_f32_bf16 v50, v169, v4
  v_dot2c_f32_bf16 v51, v169, v36
  v_dot2c_f32_bf16 v52, v170, v4
  v_dot2c_f32_bf16 v53, v170, v36
  v_dot2c_f32_bf16 v54, v171, v4
  v_dot2c_f32_bf16 v55, v171, v36
  v_dot2c_f32_bf16 v56, v172, v4
  v_dot2c_f32_bf16 v57, v172, v36
  v_dot2c_f32_bf16 v58, v173, v4
  v_dot2c_f32_bf16 v59, v173, v36
  v_dot2c_f32_bf16 v60, v174, v4
  v_dot2c_f32_bf16 v61, v174, v36
  v_dot2c_f32_bf16 v62, v175, v4
  v_dot2c_f32_bf16 v63, v175, v36
  v_dot2c_f32_bf16 v64, v176, v4
  v_dot2c_f32_bf16 v65, v176, v36
  v_dot2c_f32_bf16 v66, v177, v4
  v_dot2c_f32_bf16 v67, v177, v36
  v_dot2c_f32_bf16 v68, v178, v4
  v_dot2c_f32_bf16 v69, v178, v36
  v_dot2c_f32_bf16 v70, v179, v4
  v_dot2c_f32_bf16 v71, v179, v36
  s_waitcnt vmcnt(1)
  v_lshrrev_b32 v4, 16, v37
  v_dot2c_f32_bf16 v48, v180, v4
  v_dot2c_f32_bf16 v49, v180, v37
  v_dot2c_f32_bf16 v50, v181, v4
  v_dot2c_f32_bf16 v51, v181, v37
  v_dot2c_f32_bf16 v52, v182, v4
  v_dot2c_f32_bf16 v53, v182, v37
  v_dot2c_f32_bf16 v54, v183, v4
  v_dot2c_f32_bf16 v55, v183, v37
  v_dot2c_f32_bf16 v56, v184, v4
  v_dot2c_f32_bf16 v57, v184, v37
  v_dot2c_f32_bf16 v58, v185, v4
  v_dot2c_f32_bf16 v59, v185, v37
  v_dot2c_f32_bf16 v60, v186, v4
  v_dot2c_f32_bf16 v61, v186, v37
  v_dot2c_f32_bf16 v62, v187, v4
  v_dot2c_f32_bf16 v63, v187, v37
  v_dot2c_f32_bf16 v64, v188, v4
  v_dot2c_f32_bf16 v65, v188, v37
  v_dot2c_f32_bf16 v66, v189, v4
  v_dot2c_f32_bf16 v67, v189, v37
  v_dot2c_f32_bf16 v68, v190, v4
  v_dot2c_f32_bf16 v69, v190, v37
  v_dot2c_f32_bf16 v70, v191, v4
  v_dot2c_f32_bf16 v71, v191, v37
  v_permlane32_swap_b32 v48, v60
  v_permlane32_swap_b32 v49, v61
  v_permlane32_swap_b32 v50, v62
  v_permlane32_swap_b32 v51, v63
  v_permlane32_swap_b32 v52, v64
  v_permlane32_swap_b32 v53, v65
  v_permlane32_swap_b32 v54, v66
  v_permlane32_swap_b32 v55, v67
  v_permlane32_swap_b32 v56, v68
  v_permlane32_swap_b32 v57, v69
  v_permlane32_swap_b32 v58, v70
  v_permlane32_swap_b32 v59, v71
  v_add_f32 v48, v48, v60
  v_add_f32 v49, v49, v61
  v_add_f32 v50, v50, v62
  v_add_f32 v51, v51, v63
  v_add_f32 v52, v52, v64
  v_add_f32 v53, v53, v65
  v_add_f32 v54, v54, v66
  v_add_f32 v55, v55, v67
  v_add_f32 v56, v56, v68
  v_add_f32 v57, v57, v69
  v_add_f32 v58, v58, v70
  v_add_f32 v59, v59, v71
  v_permlane16_swap_b32 v48, v54
  v_permlane16_swap_b32 v49, v55
  v_permlane16_swap_b32 v50, v56
  v_permlane16_swap_b32 v51, v57
  v_permlane16_swap_b32 v52, v58
  v_permlane16_swap_b32 v53, v59
  v_add_f32 v48, v48, v54
  v_add_f32 v49, v49, v55
  v_add_f32 v50, v50, v56
  v_add_f32 v51, v51, v57
  v_add_f32 v52, v52, v58
  v_add_f32 v53, v53, v59
  v_add_f32_dpp v48, v48, v48 row_ror:8 row_mask:0xf bank_mask:0xf
  v_add_f32_dpp v49, v49, v49 row_ror:8 row_mask:0xf bank_mask:0xf
  v_add_f32_dpp v50, v50, v50 row_ror:8 row_mask:0xf bank_mask:0xf
  v_add_f32_dpp v51, v51, v51 row_ror:8 row_mask:0xf bank_mask:0xf
  v_add_f32_dpp v52, v52, v52 row_ror:8 row_mask:0xf bank_mask:0xf
  v_add_f32_dpp v53, v53, v53 row_ror:8 row_mask:0xf bank_mask:0xf
  s_mov_b32 s58, 262144
  s_nop 0
L_nw_qa:
  s_waitcnt vmcnt(0)
  v_readfirstlane_b32 s46, v250
  v_readfirstlane_b32 s57, v251
  s_nop 0
  s_min_u32 s46, s46, s57
  s_cmp_lg_u32 s46, 0
  s_nop 0
  s_cbranch_scc1 L_nwok_qa
  s_sub_u32 s58, s58, 1
  s_cmp_eq_u32 s58, 0
  s_cbranch_scc1 L_nwok_qa
  s_sleep 8
  buffer_load_dwordx2 v[250:251], v3, s[52:55], 0 offen offset:8 sc1
  s_branch L_nw_qa
L_nwok_qa:
  v_mov_b32 v72, v48
  v_mov_b32 v73, v49
  v_mov_b32 v74, v50
  v_mov_b32 v75, v250
  v_mov_b32 v76, v51
  v_mov_b32 v77, v52
  v_mov_b32 v78, v53
  v_mov_b32 v79, v250
  v_and_b32 v2, 7, v0
  v_lshlrev_b32 v2, 7, v2
  v_lshrrev_b32 v4, 4, v0
  v_lshl_add_u32 v2, v4, 5, v2
  s_lshl_b32 s46, s2, 11
  s_lshl_b32 s47, s35, 10
  s_add_u32 s46, s46, s47
  s_add_u32 s46, s46, 3276800
  s_mov_b32 s60, 0x00ff00ff
  s_mov_b32 s61, 0x00ff00ff
  s_mov_b64 exec, s[60:61]
  buffer_store_dwordx4 v[72:75], v2, s[48:51], s46 offen offset:0 sc1
  buffer_store_dwordx4 v[76:79], v2, s[48:51], s46 offen offset:16 sc1
  s_mov_b64 exec, -1
  s_branch L_q_done
L_qaux:
  ds_write_b32 v3, v3 offset:15872
  ds_write_b32 v3, v3 offset:15876
  ds_write_b32 v3, v3 offset:15880
  ds_write_b32 v3, v3 offset:15884
  ds_write_b32 v3, v3 offset:15888
  ds_write_b32 v3, v3 offset:16448
  v_mov_b32 v4, -1
  ds_write_b32 v1, v4 offset:16512
  ds_write_b32 v1, v4 offset:16768
  s_branch L_q_done
L_qgather:
  buffer_load_dwordx2 v[250:251], v3, s[52:55], 0 offen offset:8 sc1
  s_mov_b32 s58, 262144
L_nw_qb:
  s_waitcnt vmcnt(0)
  v_readfirstlane_b32 s46, v250
  v_readfirstlane_b32 s57, v251
  s_nop 0
  s_min_u32 s46, s46, s57
  s_cmp_lg_u32 s46, 0
  s_nop 0
  s_cbranch_scc1 L_nwok_qb
  s_sub_u32 s58, s58, 1
  s_cmp_eq_u32 s58, 0
  s_cbranch_scc1 L_nwok_qb
  s_sleep 8
  buffer_load_dwordx2 v[250:251], v3, s[52:55], 0 offen offset:8 sc1
  s_branch L_nw_qb
L_nwok_qb:
  v_lshlrev_b32 v2, 4, v0
  s_lshl_b32 s47, s30, 14
  s_add_u32 s47, s47, 3276800
  v_and_b32 v5, 7, v0
  v_lshlrev_b32 v5, 11, v5
  v_add_u32 v5, 1008, v5
  s_mov_b32 s58, 262144
  s_mov_b64 exec, 0xff
L_q1_a:
  buffer_load_dwordx4 v[72:75], v5, s[48:51], s47 offen sc1
  s_waitcnt vmcnt(0)
  v_cmp_eq_u32 vcc, v75, v250
  s_nop 0
  s_cmp_eq_u64 vcc, exec
  s_nop 1
  s_cbranch_scc1 L_q1ok_a
  s_sub_u32 s58, s58, 1
  s_cmp_eq_u32 s58, 0
  s_cbranch_scc1 L_q1ok_a
  s_branch L_q1_a
L_q1ok_a:
  s_mov_b64 exec, -1
  s_mov_b32 s58, 262144
L_qx_a:
  s_add_u32 s46, s47, 0
  buffer_load_dwordx4 v[72:75], v2, s[48:51], s46 offen sc1
  s_add_u32 s46, s47, 2048
  buffer_load_dwordx4 v[76:79], v2, s[48:51], s46 offen sc1
  s_add_u32 s46, s47, 4096
  buffer_load_dwordx4 v[80:83], v2, s[48:51], s46 offen sc1
  s_add_u32 s46, s47, 6144
  buffer_load_dwordx4 v[84:87], v2, s[48:51], s46 offen sc1
  s_add_u32 s46, s47, 8192
  buffer_load_dwordx4 v[88:91], v2, s[48:51], s46 offen sc1
  s_add_u32 s46, s47, 10240
  buffer_load_dwordx4 v[92:95], v2, s[48:51], s46 offen sc1
  s_add_u32 s46, s47, 12288
  buffer_load_dwordx4 v[96:99], v2, s[48:51], s46 offen sc1
  s_add_u32 s46, s47, 14336
  buffer_load_dwordx4 v[100:103], v2, s[48:51], s46 offen sc1
  v_mov_b32 v5, 0
  s_waitcnt vmcnt(7)
  v_xor_b32 v6, v75, v250
  v_or_b32 v5, v5, v6
  s_waitcnt vmcnt(6)
  v_xor_b32 v6, v79, v250
  v_or_b32 v5, v5, v6
  s_waitcnt vmcnt(5)
  v_xor_b32 v6, v83, v250
  v_or_b32 v5, v5, v6
  s_waitcnt vmcnt(4)
  v_xor_b32 v6, v87, v250
  v_or_b32 v5, v5, v6
  s_waitcnt vmcnt(3)
  v_xor_b32 v6, v91, v250
  v_or_b32 v5, v5, v6
  s_waitcnt vmcnt(2)
  v_xor_b32 v6, v95, v250
  v_or_b32 v5, v5, v6
  s_waitcnt vmcnt(1)
  v_xor_b32 v6, v99, v250
  v_or_b32 v5, v5, v6
  s_waitcnt vmcnt(0)
  v_xor_b32 v6, v103, v250
  v_or_b32 v5, v5, v6
  v_cmp_eq_u32 vcc, 0, v5
  s_nop 0
  s_cmp_eq_u64 vcc, exec
  s_nop 1
  s_cbranch_scc1 L_qxok_a
  s_sub_u32 s58, s58, 1
  s_cmp_eq_u32 s58, 0
  s_cbranch_scc1 L_qxok_a
  s_branch L_qx_a
L_qxok_a:
  v_add_f32 v72, v72, v76
  v_add_f32 v72, v72, v80
  v_add_f32 v72, v72, v84
  v_add_f32 v72, v72, v88
  v_add_f32 v72, v72, v92
  v_add_f32 v72, v72, v96
  v_add_f32 v72, v72, v100
  v_add_f32 v73, v73, v77
  v_add_f32 v73, v73, v81
  v_add_f32 v73, v73, v85
  v_add_f32 v73, v73, v89
  v_add_f32 v73, v73, v93
  v_add_f32 v73, v73, v97
  v_add_f32 v73, v73, v101
  v_add_f32 v74, v74, v78
  v_add_f32 v74, v74, v82
  v_add_f32 v74, v74, v86
  v_add_f32 v74, v74, v90
  v_add_f32 v74, v74, v94
  v_add_f32 v74, v74, v98
  v_add_f32 v74, v74, v102
  v_cvt_pk_bf16_f32 v6, v72, v73
  v_cvt_pk_bf16_f32 v7, v74, v74
  v_mul_u32_u24 v4, 6, v0
  ds_write_b16 v4, v6 offset:8192
  ds_write_b16_d16_hi v4, v6 offset:8194
  ds_write_b16 v4, v7 offset:8196
L_q_done:
  s_waitcnt lgkmcnt(0)
  s_barrier
  s_cmp_lg_u32 s35, 2
  s_cbranch_scc1 L_q2_done
  v_lshlrev_b32 v2, 4, v0
  s_lshl_b32 s47, s30, 14
  s_add_u32 s47, s47, 3277824
  v_and_b32 v5, 7, v0
  v_lshlrev_b32 v5, 11, v5
  v_add_u32 v5, 1008, v5
  s_mov_b32 s58, 262144
  s_mov_b64 exec, 0xff
L_q1_b:
  buffer_load_dwordx4 v[72:75], v5, s[48:51], s47 offen sc1
  s_waitcnt vmcnt(0)
  v_cmp_eq_u32 vcc, v75, v250
  s_nop 0
  s_cmp_eq_u64 vcc, exec
  s_nop 1
  s_cbranch_scc1 L_q1ok_b
  s_sub_u32 s58, s58, 1
  s_cmp_eq_u32 s58, 0
  s_cbranch_scc1 L_q1ok_b
  s_branch L_q1_b
L_q1ok_b:
  s_mov_b64 exec, -1
  s_mov_b32 s58, 262144
L_qx_b:
  s_add_u32 s46, s47, 0
  buffer_load_dwordx4 v[72:75], v2, s[48:51], s46 offen sc1
  s_add_u32 s46, s47, 2048
  buffer_load_dwordx4 v[76:79], v2, s[48:51], s46 offen sc1
  s_add_u32 s46, s47, 4096
  buffer_load_dwordx4 v[80:83], v2, s[48:51], s46 offen sc1
  s_add_u32 s46, s47, 6144
  buffer_load_dwordx4 v[84:87], v2, s[48:51], s46 offen sc1
  s_add_u32 s46, s47, 8192
  buffer_load_dwordx4 v[88:91], v2, s[48:51], s46 offen sc1
  s_add_u32 s46, s47, 10240
  buffer_load_dwordx4 v[92:95], v2, s[48:51], s46 offen sc1
  s_add_u32 s46, s47, 12288
  buffer_load_dwordx4 v[96:99], v2, s[48:51], s46 offen sc1
  s_add_u32 s46, s47, 14336
  buffer_load_dwordx4 v[100:103], v2, s[48:51], s46 offen sc1
  v_mov_b32 v5, 0
  s_waitcnt vmcnt(7)
  v_xor_b32 v6, v75, v250
  v_or_b32 v5, v5, v6
  s_waitcnt vmcnt(6)
  v_xor_b32 v6, v79, v250
  v_or_b32 v5, v5, v6
  s_waitcnt vmcnt(5)
  v_xor_b32 v6, v83, v250
  v_or_b32 v5, v5, v6
  s_waitcnt vmcnt(4)
  v_xor_b32 v6, v87, v250
  v_or_b32 v5, v5, v6
  s_waitcnt vmcnt(3)
  v_xor_b32 v6, v91, v250
  v_or_b32 v5, v5, v6
  s_waitcnt vmcnt(2)
  v_xor_b32 v6, v95, v250
  v_or_b32 v5, v5, v6
  s_waitcnt vmcnt(1)
  v_xor_b32 v6, v99, v250
  v_or_b32 v5, v5, v6
  s_waitcnt vmcnt(0)
  v_xor_b32 v6, v103, v250
  v_or_b32 v5, v5, v6
  v_cmp_eq_u32 vcc, 0, v5
  s_nop 0
  s_cmp_eq_u64 vcc, exec
  s_nop 1
  s_cbranch_scc1 L_qxok_b
  s_sub_u32 s58, s58, 1
  s_cmp_eq_u32 s58, 0
  s_cbranch_scc1 L_qxok_b
  s_branch L_qx_b
L_qxok_b:
  v_add_f32 v72, v72, v76
  v_add_f32 v72, v72, v80
  v_add_f32 v72, v72, v84
  v_add_f32 v72, v72, v88
  v_add_f32 v72, v72, v92
  v_add_f32 v72, v72, v96
  v_add_f32 v72, v72, v100
  v_add_f32 v73, v73, v77
  v_add_f32 v73, v73, v81
  v_add_f32 v73, v73, v85
  v_add_f32 v73, v73, v89
  v_add_f32 v73, v73, v93
  v_add_f32 v73, v73, v97
  v_add_f32 v73, v73, v101
  v_add_f32 v74, v74, v78
  v_add_f32 v74, v74, v82
  v_add_f32 v74, v74, v86
  v_add_f32 v74, v74, v90
  v_add_f32 v74, v74, v94
  v_add_f32 v74, v74, v98
  v_add_f32 v74, v74, v102
  v_cvt_pk_bf16_f32 v6, v72, v73
  v_cvt_pk_bf16_f32 v7, v74, v74
  v_mul_u32_u24 v4, 6, v0
  ds_write_b16 v4, v6 offset:8576
  ds_write_b16_d16_hi v4, v6 offset:8578
  ds_write_b16 v4, v7 offset:8580
  s_waitcnt lgkmcnt(0)
  v_mov_b32 v4, 1
  ds_write_b32 v3, v4 offset:15880
  s_nop 0
L_q2_done:
  s_cmp_lg_u32 s35, 3
  s_cbranch_scc1 L_agent_done
  v_mov_b32 v3, 0
  s_mov_b32 s58, 262144
  s_nop 0
L_lw_ag:
  ds_read_b32 v4, v3 offset:15876
  s_waitcnt lgkmcnt(0)
  v_readfirstlane_b32 s46, v4
  s_nop 0
  s_cmp_ge_u32 s46, 1
  s_nop 1
  s_cbranch_scc1 L_lwok_ag
  s_sub_u32 s58, s58, 1
  s_cmp_eq_u32 s58, 0
  s_cbranch_scc1 L_lwok_ag
  s_sleep 32
  s_branch L_lw_ag
L_lwok_ag:
  s_lshr_b32 s46, s2, 3
  s_lshl_b32 s46, s46, 8
  s_add_u32 s46, s46, 3145728
  v_mov_b32 v5, s46
  v_mov_b32 v6, 16512
  s_mov_b32 s56, 1
  s_mov_b32 s57, 1888
  s_mov_b64 exec, 1
L_agent:
  s_mov_b32 s58, 2097152
L_agent_wait:
  ds_read_b32 v4, v3 offset:16448
  s_waitcnt lgkmcnt(0)
  v_readfirstlane_b32 s46, v4
  s_nop 0
  s_cmp_ge_u32 s46, s56
  s_nop 1
  s_cbranch_scc1 L_agent_go
  s_sub_u32 s58, s58, 1
  s_cmp_eq_u32 s58, 0
  s_cbranch_scc1 L_agent_go
  s_sleep 2
  s_branch L_agent_wait
L_agent_go:
  v_mov_b32 v4, 4
  buffer_atomic_add v4, v5, s[48:51], 0 offen sc0 sc1
  s_waitcnt vmcnt(0)
  v_add_u32 v4, 1888, v4
  ds_write_b32 v6, v4
  v_readfirstlane_b32 s46, v4
  v_add_u32 v6, 4, v6
  s_add_u32 s56, s56, 1
  s_cmp_lt_u32 s46, 2048
  s_nop 0
  s_cbranch_scc0 L_agent_end
  s_cmp_lt_u32 s56, 120
  s_cbranch_scc1 L_agent
L_agent_end:
  v_mov_b32 v7, 1
  ds_write_b32 v3, v7 offset:15884
  s_mov_b64 exec, -1
L_agent_done:
  v_lshrrev_b32 v2, 3, v0
  v_and_b32 v3, 7, v0
  v_lshlrev_b32 v4, 4, v3
  v_lshl_add_u32 v243, v2, 11, v4
  v_min_u32 v3, 5, v3
  v_lshlrev_b32 v3, 4, v3
  v_mul_u32_u24 v2, 96, v2
  v_add_u32 v242, v2, v3
  v_lshrrev_b32 v4, 5, v0
  v_mul_u32_u24 v4, 1280, v4
  v_and_b32 v5, 7, v0
  v_lshl_add_u32 v4, v5, 2, v4
  v_bfe_u32 v5, v0, 4, 1
  v_lshl_add_u32 v245, v5, 1, v4
  s_cmp_lg_u32 s35, 0
  s_cbranch_scc1 L_side_done
  v_mov_b32 v8, -1
  v_mov_b32 v9, -1
  v_mov_b32 v10, -1
  v_mov_b32 v11, -1
  v_and_b32 v4, 7, v0
  v_lshlrev_b32 v4, 4, v4
  v_lshrrev_b32 v5, 3, v0
  v_lshl_add_u32 v4, v5, 11, v4
  s_lshl_b32 s46, s30, 14
  s_lshl_b32 s47, s28, 7
  s_add_u32 s46, s46, s47
  buffer_store_dwordx4 v[8:11], v4, s[48:51], s46 offen sc1
  s_add_u32 s46, s46, 1024
  buffer_store_dwordx4 v[8:11], v4, s[48:51], s46 offen sc1
  v_lshlrev_b32 v2, 4, v0
  s_mul_i32 s46, s2, 5120
  s_add_u32 s46, s46, 524288
  buffer_store_dwordx4 v[8:11], v2, s[48:51], s46 offen sc1
  s_add_u32 s46, s46, 1024
  buffer_store_dwordx4 v[8:11], v2, s[48:51], s46 offen sc1
  s_add_u32 s46, s46, 1024
  buffer_store_dwordx4 v[8:11], v2, s[48:51], s46 offen sc1
  s_add_u32 s46, s46, 1024
  buffer_store_dwordx4 v[8:11], v2, s[48:51], s46 offen sc1
  s_add_u32 s46, s46, 1024
  buffer_store_dwordx4 v[8:11], v2, s[48:51], s46 offen sc1
  s_add_u32 s46, s46, 1024
  s_cmp_lg_u32 s28, 0
  s_cbranch_scc1 L_tk_doneb
  s_lshr_b32 s46, s2, 3
  s_lshl_b32 s46, s46, 8
  s_add_u32 s46, s46, 3145728
  v_mov_b32 v12, 0
  s_mov_b64 exec, 1
  buffer_store_dword v12, v12, s[48:51], s46 offen sc1
  s_mov_b64 exec, -1
L_tk_doneb:
  s_cmp_ge_u32 s2, 240
  s_cbranch_scc1 L_yf_rstb
  s_mul_i32 s46, s2, 6554
  s_lshr_b32 s46, s46, 16
  s_mul_i32 s47, s46, 10
  s_sub_u32 s47, s2, s47
  s_mul_i32 s46, s46, 5120
  s_lshl_b32 s47, s47, 9
  s_add_u32 s46, s46, s47
  s_add_u32 s46, s46, 1835008
  s_mov_b32 exec_lo, 0xffffffff
  s_mov_b32 exec_hi, 0x0
  buffer_store_dwordx4 v[8:11], v2, s[48:51], s46 offen sc1
  s_mov_b64 exec, -1
  s_nop 0
L_yf_rstb:
  s_mul_i32 s59, s2, 6554
  s_lshr_b32 s59, s59, 16
  s_mul_i32 s46, s59, 10
  s_sub_u32 s57, s2, s46
  s_cmp_ge_u32 s2, 240
  s_cbranch_scc1 L_f1_done
  s_mul_i32 s46, s59, 5120
  s_lshl_b32 s47, s57, 9
  s_add_u32 s46, s46, s47
  s_add_u32 s74, s46, 1835008
  s_mov_b32 s36, s16
  s_mov_b32 s37, s17
  s_mov_b32 s38, 1966080
  s_mov_b32 s39, 0x20000
  s_mov_b32 s40, s18
  s_mov_b32 s41, s19
  s_mov_b32 s42, 1966080
  s_mov_b32 s43, 0x20000
  v_lshrrev_b32 v3, 3, v0
  v_lshlrev_b32 v4, 3, v3
  s_lshl_b32 s46, s57, 6
  v_add_u32 v4, s46, v4
  v_lshlrev_b32 v5, 2, v4
  v_mul_u32_u24 v4, 3072, v4
  v_and_b32 v7, 7, v0
  v_lshl_add_u32 v4, v7, 4, v4
  s_lshl_b32 s46, s59, 7
  buffer_load_dwordx4 v[72:75], v4, s[36:39], s46 offen nt
  buffer_load_dwordx4 v[104:107], v4, s[40:43], s46 offen nt
  s_add_u32 s46, s46, 3072
  buffer_load_dwordx4 v[76:79], v4, s[36:39], s46 offen nt
  buffer_load_dwordx4 v[108:111], v4, s[40:43], s46 offen nt
  s_add_u32 s46, s46, 3072
  buffer_load_dwordx4 v[80:83], v4, s[36:39], s46 offen nt
  buffer_load_dwordx4 v[112:115], v4, s[40:43], s46 offen nt
  s_add_u32 s46, s46, 3072
  buffer_load_dwordx4 v[84:87], v4, s[36:39], s46 offen nt
  buffer_load_dwordx4 v[116:119], v4, s[40:43], s46 offen nt
  s_add_u32 s46, s46, 3072
  buffer_load_dwordx4 v[88:91], v4, s[36:39], s46 offen nt
  buffer_load_dwordx4 v[120:123], v4, s[40:43], s46 offen nt
  s_add_u32 s46, s46, 3072
  buffer_load_dwordx4 v[92:95], v4, s[36:39], s46 offen nt
  buffer_load_dwordx4 v[124:127], v4, s[40:43], s46 offen nt
  s_add_u32 s46, s46, 3072
  buffer_load_dwordx4 v[96:99], v4, s[36:39], s46 offen nt
  buffer_load_dwordx4 v[128:131], v4, s[40:43], s46 offen nt
  s_add_u32 s46, s46, 3072
  buffer_load_dwordx4 v[100:103], v4, s[36:39], s46 offen nt
  buffer_load_dwordx4 v[132:135], v4, s[40:43], s46 offen nt
  s_add_u32 s46, s46, 3072
  ds_read_b128 v[28:31], v5 offset:0
  ds_read_b128 v[32:35], v5 offset:16
  ds_read_b128 v[36:39], v5 offset:2560
  ds_read_b128 v[40:43], v5 offset:2576
  v_mov_b32 v136, 0
  v_mov_b32 v137, 0
  v_mov_b32 v138, 0
  v_mov_b32 v139, 0
  v_mov_b32 v140, 0
  v_mov_b32 v141, 0
  v_mov_b32 v142, 0
  v_mov_b32 v143, 0
  v_mov_b32 v144, 0
  v_mov_b32 v145, 0
  v_mov_b32 v146, 0
  v_mov_b32 v147, 0
  v_mov_b32 v148, 0
  v_mov_b32 v149, 0
  v_mov_b32 v150, 0
  v_mov_b32 v151, 0
  v_mov_b32 v152, 0
  v_mov_b32 v153, 0
  v_mov_b32 v154, 0
  v_mov_b32 v155, 0
  v_mov_b32 v156, 0
  v_mov_b32 v157, 0
  v_mov_b32 v158, 0
  v_mov_b32 v159, 0
  v_mov_b32 v160, 0
  v_mov_b32 v161, 0
  v_mov_b32 v162, 0
  v_mov_b32 v163, 0
  v_mov_b32 v164, 0
  v_mov_b32 v165, 0
  v_mov_b32 v166, 0
  v_mov_b32 v167, 0
  s_waitcnt vmcnt(0) lgkmcnt(0)
  v_lshrrev_b32 v4, 16, v28
  v_dot2c_f32_bf16 v136, v72, v4
  v_dot2c_f32_bf16 v140, v72, v28
  v_dot2c_f32_bf16 v144, v73, v4
  v_dot2c_f32_bf16 v148, v73, v28
  v_dot2c_f32_bf16 v152, v74, v4
  v_dot2c_f32_bf16 v156, v74, v28
  v_dot2c_f32_bf16 v160, v75, v4
  v_dot2c_f32_bf16 v164, v75, v28
  v_dot2c_f32_bf16 v138, v104, v4
  v_dot2c_f32_bf16 v142, v104, v28
  v_dot2c_f32_bf16 v146, v105, v4
  v_dot2c_f32_bf16 v150, v105, v28
  v_dot2c_f32_bf16 v154, v106, v4
  v_dot2c_f32_bf16 v158, v106, v28
  v_dot2c_f32_bf16 v162, v107, v4
  v_dot2c_f32_bf16 v166, v107, v28
  v_lshrrev_b32 v4, 16, v36
  v_dot2c_f32_bf16 v137, v72, v4
  v_dot2c_f32_bf16 v141, v72, v36
  v_dot2c_f32_bf16 v145, v73, v4
  v_dot2c_f32_bf16 v149, v73, v36
  v_dot2c_f32_bf16 v153, v74, v4
  v_dot2c_f32_bf16 v157, v74, v36
  v_dot2c_f32_bf16 v161, v75, v4
  v_dot2c_f32_bf16 v165, v75, v36
  v_dot2c_f32_bf16 v139, v104, v4
  v_dot2c_f32_bf16 v143, v104, v36
  v_dot2c_f32_bf16 v147, v105, v4
  v_dot2c_f32_bf16 v151, v105, v36
  v_dot2c_f32_bf16 v155, v106, v4
  v_dot2c_f32_bf16 v159, v106, v36
  v_dot2c_f32_bf16 v163, v107, v4
  v_dot2c_f32_bf16 v167, v107, v36
  v_lshrrev_b32 v4, 16, v29
  v_dot2c_f32_bf16 v136, v76, v4
  v_dot2c_f32_bf16 v140, v76, v29
  v_dot2c_f32_bf16 v144, v77, v4
  v_dot2c_f32_bf16 v148, v77, v29
  v_dot2c_f32_bf16 v152, v78, v4
  v_dot2c_f32_bf16 v156, v78, v29
  v_dot2c_f32_bf16 v160, v79, v4
  v_dot2c_f32_bf16 v164, v79, v29
  v_dot2c_f32_bf16 v138, v108, v4
  v_dot2c_f32_bf16 v142, v108, v29
  v_dot2c_f32_bf16 v146, v109, v4
  v_dot2c_f32_bf16 v150, v109, v29
  v_dot2c_f32_bf16 v154, v110, v4
  v_dot2c_f32_bf16 v158, v110, v29
  v_dot2c_f32_bf16 v162, v111, v4
  v_dot2c_f32_bf16 v166, v111, v29
  v_lshrrev_b32 v4, 16, v37
  v_dot2c_f32_bf16 v137, v76, v4
  v_dot2c_f32_bf16 v141, v76, v37
  v_dot2c_f32_bf16 v145, v77, v4
  v_dot2c_f32_bf16 v149, v77, v37
  v_dot2c_f32_bf16 v153, v78, v4
  v_dot2c_f32_bf16 v157, v78, v37
  v_dot2c_f32_bf16 v161, v79, v4
  v_dot2c_f32_bf16 v165, v79, v37
  v_dot2c_f32_bf16 v139, v108, v4
  v_dot2c_f32_bf16 v143, v108, v37
  v_dot2c_f32_bf16 v147, v109, v4
  v_dot2c_f32_bf16 v151, v109, v37
  v_dot2c_f32_bf16 v155, v110, v4
  v_dot2c_f32_bf16 v159, v110, v37
  v_dot2c_f32_bf16 v163, v111, v4
  v_dot2c_f32_bf16 v167, v111, v37
  v_lshrrev_b32 v4, 16, v30
  v_dot2c_f32_bf16 v136, v80, v4
  v_dot2c_f32_bf16 v140, v80, v30
  v_dot2c_f32_bf16 v144, v81, v4
  v_dot2c_f32_bf16 v148, v81, v30
  v_dot2c_f32_bf16 v152, v82, v4
  v_dot2c_f32_bf16 v156, v82, v30
  v_dot2c_f32_bf16 v160, v83, v4
  v_dot2c_f32_bf16 v164, v83, v30
  v_dot2c_f32_bf16 v138, v112, v4
  v_dot2c_f32_bf16 v142, v112, v30
  v_dot2c_f32_bf16 v146, v113, v4
  v_dot2c_f32_bf16 v150, v113, v30
  v_dot2c_f32_bf16 v154, v114, v4
  v_dot2c_f32_bf16 v158, v114, v30
  v_dot2c_f32_bf16 v162, v115, v4
  v_dot2c_f32_bf16 v166, v115, v30
  v_lshrrev_b32 v4, 16, v38
  v_dot2c_f32_bf16 v137, v80, v4
  v_dot2c_f32_bf16 v141, v80, v38
  v_dot2c_f32_bf16 v145, v81, v4
  v_dot2c_f32_bf16 v149, v81, v38
  v_dot2c_f32_bf16 v153, v82, v4
  v_dot2c_f32_bf16 v157, v82, v38
  v_dot2c_f32_bf16 v161, v83, v4
  v_dot2c_f32_bf16 v165, v83, v38
  v_dot2c_f32_bf16 v139, v112, v4
  v_dot2c_f32_bf16 v143, v112, v38
  v_dot2c_f32_bf16 v147, v113, v4
  v_dot2c_f32_bf16 v151, v113, v38
  v_dot2c_f32_bf16 v155, v114, v4
  v_dot2c_f32_bf16 v159, v114, v38
  v_dot2c_f32_bf16 v163, v115, v4
  v_dot2c_f32_bf16 v167, v115, v38
  v_lshrrev_b32 v4, 16, v31
  v_dot2c_f32_bf16 v136, v84, v4
  v_dot2c_f32_bf16 v140, v84, v31
  v_dot2c_f32_bf16 v144, v85, v4
  v_dot2c_f32_bf16 v148, v85, v31
  v_dot2c_f32_bf16 v152, v86, v4
  v_dot2c_f32_bf16 v156, v86, v31
  v_dot2c_f32_bf16 v160, v87, v4
  v_dot2c_f32_bf16 v164, v87, v31
  v_dot2c_f32_bf16 v138, v116, v4
  v_dot2c_f32_bf16 v142, v116, v31
  v_dot2c_f32_bf16 v146, v117, v4
  v_dot2c_f32_bf16 v150, v117, v31
  v_dot2c_f32_bf16 v154, v118, v4
  v_dot2c_f32_bf16 v158, v118, v31
  v_dot2c_f32_bf16 v162, v119, v4
  v_dot2c_f32_bf16 v166, v119, v31
  v_lshrrev_b32 v4, 16, v39
  v_dot2c_f32_bf16 v137, v84, v4
  v_dot2c_f32_bf16 v141, v84, v39
  v_dot2c_f32_bf16 v145, v85, v4
  v_dot2c_f32_bf16 v149, v85, v39
  v_dot2c_f32_bf16 v153, v86, v4
  v_dot2c_f32_bf16 v157, v86, v39
  v_dot2c_f32_bf16 v161, v87, v4
  v_dot2c_f32_bf16 v165, v87, v39
  v_dot2c_f32_bf16 v139, v116, v4
  v_dot2c_f32_bf16 v143, v116, v39
  v_dot2c_f32_bf16 v147, v117, v4
  v_dot2c_f32_bf16 v151, v117, v39
  v_dot2c_f32_bf16 v155, v118, v4
  v_dot2c_f32_bf16 v159, v118, v39
  v_dot2c_f32_bf16 v163, v119, v4
  v_dot2c_f32_bf16 v167, v119, v39
  v_lshrrev_b32 v4, 16, v32
  v_dot2c_f32_bf16 v136, v88, v4
  v_dot2c_f32_bf16 v140, v88, v32
  v_dot2c_f32_bf16 v144, v89, v4
  v_dot2c_f32_bf16 v148, v89, v32
  v_dot2c_f32_bf16 v152, v90, v4
  v_dot2c_f32_bf16 v156, v90, v32
  v_dot2c_f32_bf16 v160, v91, v4
  v_dot2c_f32_bf16 v164, v91, v32
  v_dot2c_f32_bf16 v138, v120, v4
  v_dot2c_f32_bf16 v142, v120, v32
  v_dot2c_f32_bf16 v146, v121, v4
  v_dot2c_f32_bf16 v150, v121, v32
  v_dot2c_f32_bf16 v154, v122, v4
  v_dot2c_f32_bf16 v158, v122, v32
  v_dot2c_f32_bf16 v162, v123, v4
  v_dot2c_f32_bf16 v166, v123, v32
  v_lshrrev_b32 v4, 16, v40
  v_dot2c_f32_bf16 v137, v88, v4
  v_dot2c_f32_bf16 v141, v88, v40
  v_dot2c_f32_bf16 v145, v89, v4
  v_dot2c_f32_bf16 v149, v89, v40
  v_dot2c_f32_bf16 v153, v90, v4
  v_dot2c_f32_bf16 v157, v90, v40
  v_dot2c_f32_bf16 v161, v91, v4
  v_dot2c_f32_bf16 v165, v91, v40
  v_dot2c_f32_bf16 v139, v120, v4
  v_dot2c_f32_bf16 v143, v120, v40
  v_dot2c_f32_bf16 v147, v121, v4
  v_dot2c_f32_bf16 v151, v121, v40
  v_dot2c_f32_bf16 v155, v122, v4
  v_dot2c_f32_bf16 v159, v122, v40
  v_dot2c_f32_bf16 v163, v123, v4
  v_dot2c_f32_bf16 v167, v123, v40
  v_lshrrev_b32 v4, 16, v33
  v_dot2c_f32_bf16 v136, v92, v4
  v_dot2c_f32_bf16 v140, v92, v33
  v_dot2c_f32_bf16 v144, v93, v4
  v_dot2c_f32_bf16 v148, v93, v33
  v_dot2c_f32_bf16 v152, v94, v4
  v_dot2c_f32_bf16 v156, v94, v33
  v_dot2c_f32_bf16 v160, v95, v4
  v_dot2c_f32_bf16 v164, v95, v33
  v_dot2c_f32_bf16 v138, v124, v4
  v_dot2c_f32_bf16 v142, v124, v33
  v_dot2c_f32_bf16 v146, v125, v4
  v_dot2c_f32_bf16 v150, v125, v33
  v_dot2c_f32_bf16 v154, v126, v4
  v_dot2c_f32_bf16 v158, v126, v33
  v_dot2c_f32_bf16 v162, v127, v4
  v_dot2c_f32_bf16 v166, v127, v33
  v_lshrrev_b32 v4, 16, v41
  v_dot2c_f32_bf16 v137, v92, v4
  v_dot2c_f32_bf16 v141, v92, v41
  v_dot2c_f32_bf16 v145, v93, v4
  v_dot2c_f32_bf16 v149, v93, v41
  v_dot2c_f32_bf16 v153, v94, v4
  v_dot2c_f32_bf16 v157, v94, v41
  v_dot2c_f32_bf16 v161, v95, v4
  v_dot2c_f32_bf16 v165, v95, v41
  v_dot2c_f32_bf16 v139, v124, v4
  v_dot2c_f32_bf16 v143, v124, v41
  v_dot2c_f32_bf16 v147, v125, v4
  v_dot2c_f32_bf16 v151, v125, v41
  v_dot2c_f32_bf16 v155, v126, v4
  v_dot2c_f32_bf16 v159, v126, v41
  v_dot2c_f32_bf16 v163, v127, v4
  v_dot2c_f32_bf16 v167, v127, v41
  v_lshrrev_b32 v4, 16, v34
  v_dot2c_f32_bf16 v136, v96, v4
  v_dot2c_f32_bf16 v140, v96, v34
  v_dot2c_f32_bf16 v144, v97, v4
  v_dot2c_f32_bf16 v148, v97, v34
  v_dot2c_f32_bf16 v152, v98, v4
  v_dot2c_f32_bf16 v156, v98, v34
  v_dot2c_f32_bf16 v160, v99, v4
  v_dot2c_f32_bf16 v164, v99, v34
  v_dot2c_f32_bf16 v138, v128, v4
  v_dot2c_f32_bf16 v142, v128, v34
  v_dot2c_f32_bf16 v146, v129, v4
  v_dot2c_f32_bf16 v150, v129, v34
  v_dot2c_f32_bf16 v154, v130, v4
  v_dot2c_f32_bf16 v158, v130, v34
  v_dot2c_f32_bf16 v162, v131, v4
  v_dot2c_f32_bf16 v166, v131, v34
  v_lshrrev_b32 v4, 16, v42
  v_dot2c_f32_bf16 v137, v96, v4
  v_dot2c_f32_bf16 v141, v96, v42
  v_dot2c_f32_bf16 v145, v97, v4
  v_dot2c_f32_bf16 v149, v97, v42
  v_dot2c_f32_bf16 v153, v98, v4
  v_dot2c_f32_bf16 v157, v98, v42
  v_dot2c_f32_bf16 v161, v99, v4
  v_dot2c_f32_bf16 v165, v99, v42
  v_dot2c_f32_bf16 v139, v128, v4
  v_dot2c_f32_bf16 v143, v128, v42
  v_dot2c_f32_bf16 v147, v129, v4
  v_dot2c_f32_bf16 v151, v129, v42
  v_dot2c_f32_bf16 v155, v130, v4
  v_dot2c_f32_bf16 v159, v130, v42
  v_dot2c_f32_bf16 v163, v131, v4
  v_dot2c_f32_bf16 v167, v131, v42
  v_lshrrev_b32 v4, 16, v35
  v_dot2c_f32_bf16 v136, v100, v4
  v_dot2c_f32_bf16 v140, v100, v35
  v_dot2c_f32_bf16 v144, v101, v4
  v_dot2c_f32_bf16 v148, v101, v35
  v_dot2c_f32_bf16 v152, v102, v4
  v_dot2c_f32_bf16 v156, v102, v35
  v_dot2c_f32_bf16 v160, v103, v4
  v_dot2c_f32_bf16 v164, v103, v35
  v_dot2c_f32_bf16 v138, v132, v4
  v_dot2c_f32_bf16 v142, v132, v35
  v_dot2c_f32_bf16 v146, v133, v4
  v_dot2c_f32_bf16 v150, v133, v35
  v_dot2c_f32_bf16 v154, v134, v4
  v_dot2c_f32_bf16 v158, v134, v35
  v_dot2c_f32_bf16 v162, v135, v4
  v_dot2c_f32_bf16 v166, v135, v35
  v_lshrrev_b32 v4, 16, v43
  v_dot2c_f32_bf16 v137, v100, v4
  v_dot2c_f32_bf16 v141, v100, v43
  v_dot2c_f32_bf16 v145, v101, v4
  v_dot2c_f32_bf16 v149, v101, v43
  v_dot2c_f32_bf16 v153, v102, v4
  v_dot2c_f32_bf16 v157, v102, v43
  v_dot2c_f32_bf16 v161, v103, v4
  v_dot2c_f32_bf16 v165, v103, v43
  v_dot2c_f32_bf16 v139, v132, v4
  v_dot2c_f32_bf16 v143, v132, v43
  v_dot2c_f32_bf16 v147, v133, v4
  v_dot2c_f32_bf16 v151, v133, v43
  v_dot2c_f32_bf16 v155, v134, v4
  v_dot2c_f32_bf16 v159, v134, v43
  v_dot2c_f32_bf16 v163, v135, v4
  v_dot2c_f32_bf16 v167, v135, v43
  v_permlane32_swap_b32 v136, v152
  v_permlane32_swap_b32 v137, v153
  v_permlane32_swap_b32 v138, v154
  v_permlane32_swap_b32 v139, v155
  v_permlane32_swap_b32 v140, v156
  v_permlane32_swap_b32 v141, v157
  v_permlane32_swap_b32 v142, v158
  v_permlane32_swap_b32 v143, v159
  v_permlane32_swap_b32 v144, v160
  v_permlane32_swap_b32 v145, v161
  v_permlane32_swap_b32 v146, v162
  v_permlane32_swap_b32 v147, v163
  v_permlane32_swap_b32 v148, v164
  v_permlane32_swap_b32 v149, v165
  v_permlane32_swap_b32 v150, v166
  v_permlane32_swap_b32 v151, v167
  v_add_f32 v136, v136, v152
  v_add_f32 v137, v137, v153
  v_add_f32 v138, v138, v154
  v_add_f32 v139, v139, v155
  v_add_f32 v140, v140, v156
  v_add_f32 v141, v141, v157
  v_add_f32 v142, v142, v158
  v_add_f32 v143, v143, v159
  v_add_f32 v144, v144, v160
  v_add_f32 v145, v145, v161
  v_add_f32 v146, v146, v162
  v_add_f32 v147, v147, v163
  v_add_f32 v148, v148, v164
  v_add_f32 v149, v149, v165
  v_add_f32 v150, v150, v166
  v_add_f32 v151, v151, v167
  v_permlane16_swap_b32 v136, v144
  v_permlane16_swap_b32 v137, v145
  v_permlane16_swap_b32 v138, v146
  v_permlane16_swap_b32 v139, v147
  v_permlane16_swap_b32 v140, v148
  v_permlane16_swap_b32 v141, v149
  v_permlane16_swap_b32 v142, v150
  v_permlane16_swap_b32 v143, v151
  v_add_f32 v136, v136, v144
  v_add_f32 v137, v137, v145
  v_add_f32 v138, v138, v146
  v_add_f32 v139, v139, v147
  v_add_f32 v140, v140, v148
  v_add_f32 v141, v141, v149
  v_add_f32 v142, v142, v150
  v_add_f32 v143, v143, v151
  v_add_f32_dpp v136, v136, v136 row_ror:8 row_mask:0xf bank_mask:0xf
  v_add_f32_dpp v137, v137, v137 row_ror:8 row_mask:0xf bank_mask:0xf
  v_add_f32_dpp v138, v138, v138 row_ror:8 row_mask:0xf bank_mask:0xf
  v_add_f32_dpp v139, v139, v139 row_ror:8 row_mask:0xf bank_mask:0xf
  v_add_f32_dpp v140, v140, v140 row_ror:8 row_mask:0xf bank_mask:0xf
  v_add_f32_dpp v141, v141, v141 row_ror:8 row_mask:0xf bank_mask:0xf
  v_add_f32_dpp v142, v142, v142 row_ror:8 row_mask:0xf bank_mask:0xf
  v_add_f32_dpp v143, v143, v143 row_ror:8 row_mask:0xf bank_mask:0xf
  v_and_b32 v4, 8, v0
  v_cmp_eq_u32 vcc, 0, v4
  s_nop 1
  v_cndmask_b32 v136, v140, v136, vcc
  v_cndmask_b32 v137, v141, v137, vcc
  v_cndmask_b32 v138, v142, v138, vcc
  v_cndmask_b32 v139, v143, v139, vcc
  v_lshrrev_b32 v4, 3, v0
  v_and_b32 v7, 7, v0
  v_lshl_add_u32 v4, v7, 3, v4
  v_lshlrev_b32 v4, 4, v4
  s_lshl_b32 s46, s2, 10
  s_add_u32 s46, s46, 2097152
  buffer_store_dwordx4 v[136:139], v4, s[48:51], s46 offen sc1
  s_nop 1
L_f1_done:
  s_waitcnt vmcnt(0)
  s_mov_b32 s36, s24
  s_mov_b32 s37, s25
  s_mov_b32 s38, 256
  s_mov_b32 s39, 0x20000
  v_mov_b32 v4, 1
  v_mov_b32 v6, 0
  s_mov_b64 exec, 1
  buffer_atomic_add v4, v6, s[36:39], 0 offen sc1
  s_mov_b64 exec, -1
  s_mov_b32 s58, 262144
L_lw_mid:
  ds_read_b32 v4, v6 offset:15872
  s_waitcnt lgkmcnt(0)
  v_readfirstlane_b32 s46, v4
  s_nop 0
  s_cmp_ge_u32 s46, 4
  s_nop 1
  s_cbranch_scc1 L_lwok_mid
  s_sub_u32 s58, s58, 1
  s_cmp_eq_u32 s58, 0
  s_cbranch_scc1 L_lwok_mid
  s_sleep 32
  s_branch L_lw_mid
L_lwok_mid:
  v_mov_b32 v2, v242
  ds_read_b128 v[128:131], v2 offset:12096
  ds_read_b128 v[132:135], v2 offset:12880
  ds_read_b128 v[136:139], v2 offset:13664
  ds_read_b128 v[140:143], v2 offset:14448
  v_mov_b32 v3, 0
  ds_read_b64 v[144:145], v3 offset:12864
  ds_read_b64 v[146:147], v3 offset:13648
  ds_read_b64 v[148:149], v3 offset:14432
  ds_read_b64 v[150:151], v3 offset:15216
  s_waitcnt lgkmcnt(0)
  v_max_f32 v152, v144, v146
  v_max3_f32 v152, v152, v148, v150
  v_sub_f32 v153, v144, v152
  v_sub_f32 v154, v146, v152
  v_sub_f32 v155, v148, v152
  v_sub_f32 v156, v150, v152
  v_exp_f32 v153, v153
  v_exp_f32 v154, v154
  v_exp_f32 v155, v155
  v_exp_f32 v156, v156
  v_mul_f32 v160, v128, v153
  v_mul_f32 v161, v129, v153
  v_mul_f32 v162, v130, v153
  v_mul_f32 v163, v131, v153
  v_mul_f32 v157, v145, v153
  v_fmac_f32 v160, v132, v154
  v_fmac_f32 v161, v133, v154
  v_fmac_f32 v162, v134, v154
  v_fmac_f32 v163, v135, v154
  v_fmac_f32 v157, v147, v154
  v_fmac_f32 v160, v136, v155
  v_fmac_f32 v161, v137, v155
  v_fmac_f32 v162, v138, v155
  v_fmac_f32 v163, v139, v155
  v_fmac_f32 v157, v149, v155
  v_fmac_f32 v160, v140, v156
  v_fmac_f32 v161, v141, v156
  v_fmac_f32 v162, v142, v156
  v_fmac_f32 v163, v143, v156
  v_fmac_f32 v157, v151, v156
  v_and_b32 v2, 7, v0
  v_cmp_gt_u32 vcc, 6, v2
  s_nop 1
  v_cndmask_b32 v160, v152, v160, vcc
  v_cndmask_b32 v161, v157, v161, vcc
  v_cndmask_b32 v162, v152, v162, vcc
  v_cndmask_b32 v163, v157, v163, vcc
  s_lshl_b32 s46, s30, 14
  s_lshl_b32 s47, s28, 7
  s_add_u32 s46, s46, s47
  buffer_store_dwordx4 v[160:163], v243, s[48:51], s46 offen sc1
  v_mov_b32 v6, 0
  s_mov_b32 s58, 262144
  s_nop 0
L_cnt_poll:
  buffer_load_dword v4, v6, s[36:39], 0 offen sc1
  s_waitcnt vmcnt(0)
  v_readfirstlane_b32 s46, v4
  s_nop 0
  s_cmp_ge_u32 s46, 256
  s_nop 1
  s_cbranch_scc1 L_cnt_ok
  s_sub_u32 s58, s58, 1
  s_cmp_eq_u32 s58, 0
  s_cbranch_scc1 L_cnt_ok
  s_sleep 8
  s_branch L_cnt_poll
L_cnt_ok:
  v_mov_b32 v4, 1
  ds_write_b32 v6, v4 offset:15876
  s_cmp_ge_u32 s2, 240
  s_cbranch_scc1 L_f2_done
  v_lshlrev_b32 v2, 4, v0
  s_mul_i32 s46, s59, 10240
  s_add_u32 s46, s46, 2097152
  buffer_load_dwordx4 v[72:75], v2, s[48:51], s46 offen sc1
  s_add_u32 s46, s46, 1024
  buffer_load_dwordx4 v[76:79], v2, s[48:51], s46 offen sc1
  s_add_u32 s46, s46, 1024
  buffer_load_dwordx4 v[80:83], v2, s[48:51], s46 offen sc1
  s_add_u32 s46, s46, 1024
  buffer_load_dwordx4 v[84:87], v2, s[48:51], s46 offen sc1
  s_add_u32 s46, s46, 1024
  buffer_load_dwordx4 v[88:91], v2, s[48:51], s46 offen sc1
  s_add_u32 s46, s46, 1024
  buffer_load_dwordx4 v[92:95], v2, s[48:51], s46 offen sc1
  s_add_u32 s46, s46, 1024
  buffer_load_dwordx4 v[96:99], v2, s[48:51], s46 offen sc1
  s_add_u32 s46, s46, 1024
  buffer_load_dwordx4 v[100:103], v2, s[48:51], s46 offen sc1
  s_add_u32 s46, s46, 1024
  buffer_load_dwordx4 v[104:107], v2, s[48:51], s46 offen sc1
  s_add_u32 s46, s46, 1024
  buffer_load_dwordx4 v[108:111], v2, s[48:51], s46 offen sc1
  s_add_u32 s46, s46, 1024
  s_mov_b32 s52, s20
  s_mov_b32 s53, s21
  s_mov_b32 s54, 1966080
  s_mov_b32 s55, 0x20000
  v_lshrrev_b32 v3, 3, v0
  v_lshlrev_b32 v4, 3, v3
  v_lshlrev_b32 v5, 2, v4
  s_lshl_b32 s46, s59, 6
  v_add_u32 v4, s46, v4
  v_mul_u32_u24 v4, 1280, v4
  v_and_b32 v7, 7, v0
  v_lshl_add_u32 v4, v7, 4, v4
  s_lshl_b32 s46, s57, 7
  buffer_load_dwordx4 v[112:115], v4, s[52:55], s46 offen nt
  s_add_u32 s46, s46, 1280
  buffer_load_dwordx4 v[116:119], v4, s[52:55], s46 offen nt
  s_add_u32 s46, s46, 1280
  buffer_load_dwordx4 v[120:123], v4, s[52:55], s46 offen nt
  s_add_u32 s46, s46, 1280
  buffer_load_dwordx4 v[124:127], v4, s[52:55], s46 offen nt
  s_add_u32 s46, s46, 1280
  buffer_load_dwordx4 v[128:131], v4, s[52:55], s46 offen nt
  s_add_u32 s46, s46, 1280
  buffer_load_dwordx4 v[132:135], v4, s[52:55], s46 offen nt
  s_add_u32 s46, s46, 1280
  buffer_load_dwordx4 v[136:139], v4, s[52:55], s46 offen nt
  s_add_u32 s46, s46, 1280
  buffer_load_dwordx4 v[140:143], v4, s[52:55], s46 offen nt
  s_add_u32 s46, s46, 1280
  s_waitcnt vmcnt(8)
  v_add_f32 v72, v72, v76
  v_add_f32 v73, v73, v77
  v_add_f32 v74, v74, v78
  v_add_f32 v75, v75, v79
  v_add_f32 v72, v72, v80
  v_add_f32 v73, v73, v81
  v_add_f32 v74, v74, v82
  v_add_f32 v75, v75, v83
  v_add_f32 v72, v72, v84
  v_add_f32 v73, v73, v85
  v_add_f32 v74, v74, v86
  v_add_f32 v75, v75, v87
  v_add_f32 v72, v72, v88
  v_add_f32 v73, v73, v89
  v_add_f32 v74, v74, v90
  v_add_f32 v75, v75, v91
  v_add_f32 v72, v72, v92
  v_add_f32 v73, v73, v93
  v_add_f32 v74, v74, v94
  v_add_f32 v75, v75, v95
  v_add_f32 v72, v72, v96
  v_add_f32 v73, v73, v97
  v_add_f32 v74, v74, v98
  v_add_f32 v75, v75, v99
  v_add_f32 v72, v72, v100
  v_add_f32 v73, v73, v101
  v_add_f32 v74, v74, v102
  v_add_f32 v75, v75, v103
  v_add_f32 v72, v72, v104
  v_add_f32 v73, v73, v105
  v_add_f32 v74, v74, v106
  v_add_f32 v75, v75, v107
  v_add_f32 v72, v72, v108
  v_add_f32 v73, v73, v109
  v_add_f32 v74, v74, v110
  v_add_f32 v75, v75, v111
  v_cvt_pk_bf16_f32 v72, v72, v72
  v_and_b32 v72, 0xffff0000, v72
  v_cvt_pk_bf16_f32 v74, v74, v74
  v_and_b32 v74, 0xffff0000, v74
  v_mul_f32 v8, s34, v72
  v_exp_f32 v8, -v8
  s_nop 0
  v_add_f32 v8, 1.0, v8
  v_rcp_f32 v8, v8
  s_nop 0
  v_mul_f32 v72, v72, v8
  v_cvt_pk_bf16_f32 v72, v72, v72
  v_and_b32 v72, 0xffff0000, v72
  v_mul_f32 v72, v72, v74
  v_cvt_pk_bf16_f32 v72, v72, v72
  v_and_b32 v72, 0xffff0000, v72
  ds_write_b32 v1, v72 offset:15936
  v_cvt_pk_bf16_f32 v73, v73, v73
  v_and_b32 v73, 0xffff0000, v73
  v_cvt_pk_bf16_f32 v75, v75, v75
  v_and_b32 v75, 0xffff0000, v75
  v_mul_f32 v8, s34, v73
  v_exp_f32 v8, -v8
  s_nop 0
  v_add_f32 v8, 1.0, v8
  v_rcp_f32 v8, v8
  s_nop 0
  v_mul_f32 v73, v73, v8
  v_cvt_pk_bf16_f32 v73, v73, v73
  v_and_b32 v73, 0xffff0000, v73
  v_mul_f32 v73, v73, v75
  v_cvt_pk_bf16_f32 v73, v73, v73
  v_and_b32 v73, 0xffff0000, v73
  ds_write_b32 v1, v73 offset:16192
  s_waitcnt lgkmcnt(0)
  ds_read_b128 v[28:31], v5 offset:15936
  ds_read_b128 v[32:35], v5 offset:15952
  ds_read_b128 v[36:39], v5 offset:16192
  ds_read_b128 v[40:43], v5 offset:16208
  v_mov_b32 v76, 0
  v_mov_b32 v77, 0
  v_mov_b32 v78, 0
  v_mov_b32 v79, 0
  v_mov_b32 v80, 0
  v_mov_b32 v81, 0
  v_mov_b32 v82, 0
  v_mov_b32 v83, 0
  v_mov_b32 v84, 0
  v_mov_b32 v85, 0
  v_mov_b32 v86, 0
  v_mov_b32 v87, 0
  v_mov_b32 v88, 0
  v_mov_b32 v89, 0
  v_mov_b32 v90, 0
  v_mov_b32 v91, 0
  s_waitcnt vmcnt(0) lgkmcnt(0)
  v_lshrrev_b32 v4, 16, v28
  v_dot2c_f32_bf16 v76, v112, v4
  v_dot2c_f32_bf16 v77, v112, v28
  v_dot2c_f32_bf16 v80, v113, v4
  v_dot2c_f32_bf16 v81, v113, v28
  v_dot2c_f32_bf16 v84, v114, v4
  v_dot2c_f32_bf16 v85, v114, v28
  v_dot2c_f32_bf16 v88, v115, v4
  v_dot2c_f32_bf16 v89, v115, v28
  v_lshrrev_b32 v4, 16, v36
  v_dot2c_f32_bf16 v78, v112, v4
  v_dot2c_f32_bf16 v79, v112, v36
  v_dot2c_f32_bf16 v82, v113, v4
  v_dot2c_f32_bf16 v83, v113, v36
  v_dot2c_f32_bf16 v86, v114, v4
  v_dot2c_f32_bf16 v87, v114, v36
  v_dot2c_f32_bf16 v90, v115, v4
  v_dot2c_f32_bf16 v91, v115, v36
  v_lshrrev_b32 v4, 16, v29
  v_dot2c_f32_bf16 v76, v116, v4
  v_dot2c_f32_bf16 v77, v116, v29
  v_dot2c_f32_bf16 v80, v117, v4
  v_dot2c_f32_bf16 v81, v117, v29
  v_dot2c_f32_bf16 v84, v118, v4
  v_dot2c_f32_bf16 v85, v118, v29
  v_dot2c_f32_bf16 v88, v119, v4
  v_dot2c_f32_bf16 v89, v119, v29
  v_lshrrev_b32 v4, 16, v37
  v_dot2c_f32_bf16 v78, v116, v4
  v_dot2c_f32_bf16 v79, v116, v37
  v_dot2c_f32_bf16 v82, v117, v4
  v_dot2c_f32_bf16 v83, v117, v37
  v_dot2c_f32_bf16 v86, v118, v4
  v_dot2c_f32_bf16 v87, v118, v37
  v_dot2c_f32_bf16 v90, v119, v4
  v_dot2c_f32_bf16 v91, v119, v37
  v_lshrrev_b32 v4, 16, v30
  v_dot2c_f32_bf16 v76, v120, v4
  v_dot2c_f32_bf16 v77, v120, v30
  v_dot2c_f32_bf16 v80, v121, v4
  v_dot2c_f32_bf16 v81, v121, v30
  v_dot2c_f32_bf16 v84, v122, v4
  v_dot2c_f32_bf16 v85, v122, v30
  v_dot2c_f32_bf16 v88, v123, v4
  v_dot2c_f32_bf16 v89, v123, v30
  v_lshrrev_b32 v4, 16, v38
  v_dot2c_f32_bf16 v78, v120, v4
  v_dot2c_f32_bf16 v79, v120, v38
  v_dot2c_f32_bf16 v82, v121, v4
  v_dot2c_f32_bf16 v83, v121, v38
  v_dot2c_f32_bf16 v86, v122, v4
  v_dot2c_f32_bf16 v87, v122, v38
  v_dot2c_f32_bf16 v90, v123, v4
  v_dot2c_f32_bf16 v91, v123, v38
  v_lshrrev_b32 v4, 16, v31
  v_dot2c_f32_bf16 v76, v124, v4
  v_dot2c_f32_bf16 v77, v124, v31
  v_dot2c_f32_bf16 v80, v125, v4
  v_dot2c_f32_bf16 v81, v125, v31
  v_dot2c_f32_bf16 v84, v126, v4
  v_dot2c_f32_bf16 v85, v126, v31
  v_dot2c_f32_bf16 v88, v127, v4
  v_dot2c_f32_bf16 v89, v127, v31
  v_lshrrev_b32 v4, 16, v39
  v_dot2c_f32_bf16 v78, v124, v4
  v_dot2c_f32_bf16 v79, v124, v39
  v_dot2c_f32_bf16 v82, v125, v4
  v_dot2c_f32_bf16 v83, v125, v39
  v_dot2c_f32_bf16 v86, v126, v4
  v_dot2c_f32_bf16 v87, v126, v39
  v_dot2c_f32_bf16 v90, v127, v4
  v_dot2c_f32_bf16 v91, v127, v39
  v_lshrrev_b32 v4, 16, v32
  v_dot2c_f32_bf16 v76, v128, v4
  v_dot2c_f32_bf16 v77, v128, v32
  v_dot2c_f32_bf16 v80, v129, v4
  v_dot2c_f32_bf16 v81, v129, v32
  v_dot2c_f32_bf16 v84, v130, v4
  v_dot2c_f32_bf16 v85, v130, v32
  v_dot2c_f32_bf16 v88, v131, v4
  v_dot2c_f32_bf16 v89, v131, v32
  v_lshrrev_b32 v4, 16, v40
  v_dot2c_f32_bf16 v78, v128, v4
  v_dot2c_f32_bf16 v79, v128, v40
  v_dot2c_f32_bf16 v82, v129, v4
  v_dot2c_f32_bf16 v83, v129, v40
  v_dot2c_f32_bf16 v86, v130, v4
  v_dot2c_f32_bf16 v87, v130, v40
  v_dot2c_f32_bf16 v90, v131, v4
  v_dot2c_f32_bf16 v91, v131, v40
  v_lshrrev_b32 v4, 16, v33
  v_dot2c_f32_bf16 v76, v132, v4
  v_dot2c_f32_bf16 v77, v132, v33
  v_dot2c_f32_bf16 v80, v133, v4
  v_dot2c_f32_bf16 v81, v133, v33
  v_dot2c_f32_bf16 v84, v134, v4
  v_dot2c_f32_bf16 v85, v134, v33
  v_dot2c_f32_bf16 v88, v135, v4
  v_dot2c_f32_bf16 v89, v135, v33
  v_lshrrev_b32 v4, 16, v41
  v_dot2c_f32_bf16 v78, v132, v4
  v_dot2c_f32_bf16 v79, v132, v41
  v_dot2c_f32_bf16 v82, v133, v4
  v_dot2c_f32_bf16 v83, v133, v41
  v_dot2c_f32_bf16 v86, v134, v4
  v_dot2c_f32_bf16 v87, v134, v41
  v_dot2c_f32_bf16 v90, v135, v4
  v_dot2c_f32_bf16 v91, v135, v41
  v_lshrrev_b32 v4, 16, v34
  v_dot2c_f32_bf16 v76, v136, v4
  v_dot2c_f32_bf16 v77, v136, v34
  v_dot2c_f32_bf16 v80, v137, v4
  v_dot2c_f32_bf16 v81, v137, v34
  v_dot2c_f32_bf16 v84, v138, v4
  v_dot2c_f32_bf16 v85, v138, v34
  v_dot2c_f32_bf16 v88, v139, v4
  v_dot2c_f32_bf16 v89, v139, v34
  v_lshrrev_b32 v4, 16, v42
  v_dot2c_f32_bf16 v78, v136, v4
  v_dot2c_f32_bf16 v79, v136, v42
  v_dot2c_f32_bf16 v82, v137, v4
  v_dot2c_f32_bf16 v83, v137, v42
  v_dot2c_f32_bf16 v86, v138, v4
  v_dot2c_f32_bf16 v87, v138, v42
  v_dot2c_f32_bf16 v90, v139, v4
  v_dot2c_f32_bf16 v91, v139, v42
  v_lshrrev_b32 v4, 16, v35
  v_dot2c_f32_bf16 v76, v140, v4
  v_dot2c_f32_bf16 v77, v140, v35
  v_dot2c_f32_bf16 v80, v141, v4
  v_dot2c_f32_bf16 v81, v141, v35
  v_dot2c_f32_bf16 v84, v142, v4
  v_dot2c_f32_bf16 v85, v142, v35
  v_dot2c_f32_bf16 v88, v143, v4
  v_dot2c_f32_bf16 v89, v143, v35
  v_lshrrev_b32 v4, 16, v43
  v_dot2c_f32_bf16 v78, v140, v4
  v_dot2c_f32_bf16 v79, v140, v43
  v_dot2c_f32_bf16 v82, v141, v4
  v_dot2c_f32_bf16 v83, v141, v43
  v_dot2c_f32_bf16 v86, v142, v4
  v_dot2c_f32_bf16 v87, v142, v43
  v_dot2c_f32_bf16 v90, v143, v4
  v_dot2c_f32_bf16 v91, v143, v43
  v_permlane32_swap_b32 v76, v84
  v_permlane32_swap_b32 v77, v85
  v_permlane32_swap_b32 v78, v86
  v_permlane32_swap_b32 v79, v87
  v_permlane32_swap_b32 v80, v88
  v_permlane32_swap_b32 v81, v89
  v_permlane32_swap_b32 v82, v90
  v_permlane32_swap_b32 v83, v91
  v_add_f32 v76, v76, v84
  v_add_f32 v77, v77, v85
  v_add_f32 v78, v78, v86
  v_add_f32 v79, v79, v87
  v_add_f32 v80, v80, v88
  v_add_f32 v81, v81, v89
  v_add_f32 v82, v82, v90
  v_add_f32 v83, v83, v91
  v_permlane16_swap_b32 v76, v80
  v_permlane16_swap_b32 v77, v81
  v_permlane16_swap_b32 v78, v82
  v_permlane16_swap_b32 v79, v83
  v_add_f32 v76, v76, v80
  v_add_f32 v77, v77, v81
  v_add_f32 v78, v78, v82
  v_add_f32 v79, v79, v83
  v_add_f32_dpp v76, v76, v76 row_ror:8 row_mask:0xf bank_mask:0xf
  v_add_f32_dpp v77, v77, v77 row_ror:8 row_mask:0xf bank_mask:0xf
  v_add_f32_dpp v78, v78, v78 row_ror:8 row_mask:0xf bank_mask:0xf
  v_add_f32_dpp v79, v79, v79 row_ror:8 row_mask:0xf bank_mask:0xf
  v_and_b32 v7, 7, v0
  v_lshrrev_b32 v4, 4, v0
  v_lshl_add_u32 v4, v7, 2, v4
  v_lshlrev_b32 v4, 4, v4
  s_mov_b32 s46, 0x00ff00ff
  s_mov_b32 s47, 0x00ff00ff
  s_mov_b64 exec, s[46:47]
  buffer_store_dwordx4 v[76:79], v4, s[48:51], s74 offen sc1
  s_mov_b64 exec, -1
  s_nop 0
L_f2_done:
  s_cmp_ge_u32 s2, 40
  s_cbranch_scc1 L_side_done
  v_lshrrev_b32 v3, 3, v0
  v_mul_u32_u24 v3, 5120, v3
  v_and_b32 v4, 7, v0
  v_lshl_add_u32 v3, v4, 4, v3
  s_lshl_b32 s47, s2, 7
  s_add_u32 s47, s47, 1835008
  s_mov_b32 s58, 262144
L_yf_poll:
  s_mov_b32 s46, s47
  buffer_load_dwordx4 v[72:75], v3, s[48:51], s46 offen sc1
  s_add_u32 s46, s46, 40960
  buffer_load_dwordx4 v[76:79], v3, s[48:51], s46 offen sc1
  s_add_u32 s46, s46, 40960
  buffer_load_dwordx4 v[80:83], v3, s[48:51], s46 offen sc1
  s_add_u32 s46, s46, 40960
  s_waitcnt vmcnt(0)
  v_max3_u32 v5, v72, v73, v74
  v_max3_u32 v5, v5, v75, v76
  v_max3_u32 v5, v5, v77, v78
  v_max3_u32 v5, v5, v79, v80
  v_max3_u32 v5, v5, v81, v82
  v_max_u32 v5, v5, v83
  v_cmp_ne_u32 vcc, -1, v5
  s_nop 0
  s_cmp_eq_u64 vcc, exec
  s_nop 1
  s_cbranch_scc1 L_yf_ok
  s_sub_u32 s58, s58, 1
  s_cmp_eq_u32 s58, 0
  s_cbranch_scc1 L_yf_ok
  s_sleep 16
  s_branch L_yf_poll
L_yf_ok:
  v_add_f32 v72, v72, v76
  v_add_f32 v72, v72, v80
  v_add_f32 v73, v73, v77
  v_add_f32 v73, v73, v81
  v_add_f32 v74, v74, v78
  v_add_f32 v74, v74, v82
  v_add_f32 v75, v75, v79
  v_add_f32 v75, v75, v83
  v_add_f32_dpp v72, v72, v72 row_ror:8 row_mask:0xf bank_mask:0xf
  v_add_f32_dpp v73, v73, v73 row_ror:8 row_mask:0xf bank_mask:0xf
  v_add_f32_dpp v74, v74, v74 row_ror:8 row_mask:0xf bank_mask:0xf
  v_add_f32_dpp v75, v75, v75 row_ror:8 row_mask:0xf bank_mask:0xf
  s_nop 0
  v_permlane32_swap_b32 v72, v74
  v_permlane32_swap_b32 v73, v75
  v_add_f32 v72, v72, v74
  v_add_f32 v73, v73, v75
  s_nop 1
  v_permlane16_swap_b32 v72, v73
  v_add_f32 v244, v72, v73
  v_cvt_pk_bf16_f32 v244, v244, v244
  v_and_b32 v244, 0xffff0000, v244
  v_mul_f32 v4, s34, v244
  v_exp_f32 v4, -v4
  s_nop 0
  v_add_f32 v4, 1.0, v4
  v_rcp_f32 v4, v4
  s_nop 0
  v_mul_f32 v244, v244, v4
  v_cvt_pk_bf16_f32 v244, v244, v244
  v_and_b32 v244, 0xffff0000, v244
  s_mov_b32 s36, s4
  s_mov_b32 s37, s5
  s_mov_b32 s38, 2560
  s_mov_b32 s39, 0x20000
  s_lshl_b32 s46, s2, 5
  buffer_load_ushort v248, v245, s[36:39], s46 offen
L_side_done:
  s_waitcnt vmcnt(0)
  v_and_b32 v3, 7, v0
  v_min_u32 v3, 6, v3
  v_lshlrev_b32 v4, 4, v3
  v_lshrrev_b32 v5, 3, v0
  v_lshl_add_u32 v241, v5, 7, v4
  s_lshl_b32 s62, s30, 14
  s_lshl_b32 s46, s28, 11
  s_add_u32 s62, s62, s46
  s_add_u32 s63, s62, 1024
  v_lshrrev_b32 v4, 5, v0
  v_mul_u32_u24 v4, 48, v4
  v_and_b32 v5, 7, v0
  v_lshl_add_u32 v4, v5, 3, v4
  v_bfe_u32 v5, v0, 4, 1
  v_lshl_add_u32 v240, v5, 1, v4
  v_and_b32 v5, 8, v0
  v_cmp_eq_u32 s[56:57], 0, v5
  s_cmp_eq_u32 s35, 0
  s_nop 2
  s_cbranch_scc1 L_wo_issued
  v_mov_b32 v3, 0
  s_mov_b32 s58, 262144
  s_nop 0
L_lw_nd:
  ds_read_b32 v4, v3 offset:16448
  s_waitcnt lgkmcnt(0)
  v_readfirstlane_b32 s46, v4
  s_nop 0
  s_cmp_ge_u32 s46, 1
  s_nop 1
  s_cbranch_scc1 L_lwok_nd
  s_sub_u32 s58, s58, 1
  s_cmp_eq_u32 s58, 0
  s_cbranch_scc1 L_lwok_nd
  s_sleep 32
  s_branch L_lw_nd
L_lwok_nd:
  s_mov_b32 s58, 2097152
L_lw_f5:
  ds_read_b32 v4, v3 offset:15884
  s_waitcnt lgkmcnt(0)
  v_readfirstlane_b32 s46, v4
  s_nop 0
  s_cmp_ge_u32 s46, 1
  s_nop 1
  s_cbranch_scc1 L_lwok_f5
  s_sub_u32 s58, s58, 1
  s_cmp_eq_u32 s58, 0
  s_cbranch_scc1 L_lwok_f5
  s_sleep 1
  s_branch L_lw_f5
L_lwok_f5:
  s_mov_b32 s58, 2097152
L_lw_dn2:
  ds_read_b32 v4, v3 offset:15888
  s_waitcnt lgkmcnt(0)
  v_readfirstlane_b32 s46, v4
  s_nop 0
  s_cmp_ge_u32 s46, 1
  s_nop 1
  s_cbranch_scc1 L_lwok_dn2
  s_sub_u32 s58, s58, 1
  s_cmp_eq_u32 s58, 0
  s_cbranch_scc1 L_lwok_dn2
  s_sleep 1
  s_branch L_lw_dn2
L_lwok_dn2:
  s_mov_b32 s40, s12
  s_mov_b32 s41, s13
  s_mov_b32 s42, 7864320
  s_mov_b32 s43, 0x20000
  s_mul_i32 s46, s30, 192
  s_lshl_b32 s47, s28, 3
  s_add_u32 s46, s46, s47
  s_mul_i32 s46, s46, 1280
  s_mul_i32 s47, s35, 432
  s_sub_u32 s47, s47, 432
  s_add_u32 s46, s46, s47
  v_lshlrev_b32 v2, 3, v0
  s_cmp_eq_u32 s35, 3
  s_cselect_b32 s59, 2, 0
  s_lshr_b32 exec_hi, 0x3fffff, s59
  s_add_u32 s47, s46, 0
  buffer_load_dwordx2 v[192:193], v2, s[40:43], s47 offen nt
  s_add_u32 s47, s46, 1280
  buffer_load_dwordx2 v[194:195], v2, s[40:43], s47 offen nt
  s_add_u32 s47, s46, 2560
  buffer_load_dwordx2 v[196:197], v2, s[40:43], s47 offen nt
  s_add_u32 s47, s46, 3840
  buffer_load_dwordx2 v[198:199], v2, s[40:43], s47 offen nt
  s_add_u32 s47, s46, 5120
  buffer_load_dwordx2 v[200:201], v2, s[40:43], s47 offen nt
  s_add_u32 s47, s46, 6400
  buffer_load_dwordx2 v[202:203], v2, s[40:43], s47 offen nt
  s_add_u32 s47, s46, 7680
  buffer_load_dwordx2 v[204:205], v2, s[40:43], s47 offen nt
  s_add_u32 s47, s46, 8960
  buffer_load_dwordx2 v[206:207], v2, s[40:43], s47 offen nt
  s_add_u32 s47, s46, 81920
  buffer_load_dwordx2 v[208:209], v2, s[40:43], s47 offen nt
  s_add_u32 s47, s46, 83200
  buffer_load_dwordx2 v[210:211], v2, s[40:43], s47 offen nt
  s_add_u32 s47, s46, 84480
  buffer_load_dwordx2 v[212:213], v2, s[40:43], s47 offen nt
  s_add_u32 s47, s46, 85760
  buffer_load_dwordx2 v[214:215], v2, s[40:43], s47 offen nt
  s_add_u32 s47, s46, 87040
  buffer_load_dwordx2 v[216:217], v2, s[40:43], s47 offen nt
  s_add_u32 s47, s46, 88320
  buffer_load_dwordx2 v[218:219], v2, s[40:43], s47 offen nt
  s_add_u32 s47, s46, 89600
  buffer_load_dwordx2 v[220:221], v2, s[40:43], s47 offen nt
  s_add_u32 s47, s46, 90880
  buffer_load_dwordx2 v[222:223], v2, s[40:43], s47 offen nt
  s_add_u32 s47, s46, 163840
  buffer_load_dwordx2 v[224:225], v2, s[40:43], s47 offen nt
  s_add_u32 s47, s46, 165120
  buffer_load_dwordx2 v[226:227], v2, s[40:43], s47 offen nt
  s_add_u32 s47, s46, 166400
  buffer_load_dwordx2 v[228:229], v2, s[40:43], s47 offen nt
  s_add_u32 s47, s46, 167680
  buffer_load_dwordx2 v[230:231], v2, s[40:43], s47 offen nt
  s_add_u32 s47, s46, 168960
  buffer_load_dwordx2 v[232:233], v2, s[40:43], s47 offen nt
  s_add_u32 s47, s46, 170240
  buffer_load_dwordx2 v[234:235], v2, s[40:43], s47 offen nt
  s_add_u32 s47, s46, 171520
  buffer_load_dwordx2 v[236:237], v2, s[40:43], s47 offen nt
  s_add_u32 s47, s46, 172800
  buffer_load_dwordx2 v[238:239], v2, s[40:43], s47 offen nt
  s_mov_b64 exec, -1
  s_branch L_wo_perm
L_wo_issued:
  v_mov_b32 v3, 0
  s_mov_b32 s58, 262144
  s_nop 0
L_lw_f5b:
  ds_read_b32 v4, v3 offset:15884
  s_waitcnt lgkmcnt(0)
  v_readfirstlane_b32 s46, v4
  s_nop 0
  s_cmp_ge_u32 s46, 1
  s_nop 1
  s_cbranch_scc1 L_lwok_f5b
  s_sub_u32 s58, s58, 1
  s_cmp_eq_u32 s58, 0
  s_cbranch_scc1 L_lwok_f5b
  s_sleep 16
  s_branch L_lw_f5b
L_lwok_f5b:
  s_mov_b32 s58, 2097152
L_lw_dn:
  ds_read_b32 v4, v3 offset:15888
  s_waitcnt lgkmcnt(0)
  v_readfirstlane_b32 s46, v4
  s_nop 0
  s_cmp_ge_u32 s46, 4
  s_nop 1
  s_cbranch_scc1 L_lwok_dn
  s_sub_u32 s58, s58, 1
  s_cmp_eq_u32 s58, 0
  s_cbranch_scc1 L_lwok_dn
  s_branch L_lw_dn
L_lwok_dn:
  v_mov_b32 v2, v242
  ds_read_b128 v[128:131], v2 offset:8960
  ds_read_b128 v[132:135], v2 offset:9744
  ds_read_b128 v[136:139], v2 offset:10528
  ds_read_b128 v[140:143], v2 offset:11312
  v_mov_b32 v3, 0
  ds_read_b64 v[144:145], v3 offset:9728
  ds_read_b64 v[146:147], v3 offset:10512
  ds_read_b64 v[148:149], v3 offset:11296
  ds_read_b64 v[150:151], v3 offset:12080
  s_waitcnt lgkmcnt(0)
  v_max_f32 v152, v144, v146
  v_max3_f32 v152, v152, v148, v150
  v_sub_f32 v153, v144, v152
  v_sub_f32 v154, v146, v152
  v_sub_f32 v155, v148, v152
  v_sub_f32 v156, v150, v152
  v_exp_f32 v153, v153
  v_exp_f32 v154, v154
  v_exp_f32 v155, v155
  v_exp_f32 v156, v156
  v_mul_f32 v160, v128, v153
  v_mul_f32 v161, v129, v153
  v_mul_f32 v162, v130, v153
  v_mul_f32 v163, v131, v153
  v_mul_f32 v157, v145, v153
  v_fmac_f32 v160, v132, v154
  v_fmac_f32 v161, v133, v154
  v_fmac_f32 v162, v134, v154
  v_fmac_f32 v163, v135, v154
  v_fmac_f32 v157, v147, v154
  v_fmac_f32 v160, v136, v155
  v_fmac_f32 v161, v137, v155
  v_fmac_f32 v162, v138, v155
  v_fmac_f32 v163, v139, v155
  v_fmac_f32 v157, v149, v155
  v_fmac_f32 v160, v140, v156
  v_fmac_f32 v161, v141, v156
  v_fmac_f32 v162, v142, v156
  v_fmac_f32 v163, v143, v156
  v_fmac_f32 v157, v151, v156
  v_and_b32 v2, 7, v0
  v_cmp_gt_u32 vcc, 6, v2
  s_nop 1
  v_cndmask_b32 v160, v152, v160, vcc
  v_cndmask_b32 v161, v157, v161, vcc
  v_cndmask_b32 v162, v152, v162, vcc
  v_cndmask_b32 v163, v157, v163, vcc
  s_lshl_b32 s46, s30, 14
  s_lshl_b32 s47, s28, 7
  s_add_u32 s46, s46, s47
  s_add_u32 s46, s46, 1024
  buffer_store_dwordx4 v[160:163], v243, s[48:51], s46 offen sc1
  s_mov_b32 s58, 262144
  s_nop 0
L_h1_poll:
  buffer_load_dwordx4 v[128:131], v241, s[48:51], s62 offen sc1
  buffer_load_dwordx4 v[132:135], v241, s[48:51], s63 offen sc1
  s_waitcnt vmcnt(0)
  v_max3_u32 v5, v128, v129, v130
  v_max3_u32 v5, v5, v131, v132
  v_max3_u32 v5, v5, v133, v134
  v_max_u32 v5, v5, v135
  v_cmp_ne_u32 vcc, -1, v5
  s_nop 0
  s_cmp_eq_u64 vcc, exec
  s_nop 1
  s_cbranch_scc1 L_h1_ok
  s_sub_u32 s58, s58, 1
  s_cmp_eq_u32 s58, 0
  s_cbranch_scc1 L_h1_ok
  s_branch L_h1_poll
L_h1_ok:
  v_mov_b32_dpp v136, v128 row_newbcast:6 row_mask:0xf bank_mask:0xf
  v_mov_b32_dpp v137, v128 row_newbcast:14 row_mask:0xf bank_mask:0xf
  v_mov_b32_dpp v138, v129 row_newbcast:6 row_mask:0xf bank_mask:0xf
  v_mov_b32_dpp v139, v129 row_newbcast:14 row_mask:0xf bank_mask:0xf
  v_mov_b32_dpp v144, v132 row_newbcast:6 row_mask:0xf bank_mask:0xf
  v_mov_b32_dpp v145, v132 row_newbcast:14 row_mask:0xf bank_mask:0xf
  v_mov_b32_dpp v146, v133 row_newbcast:6 row_mask:0xf bank_mask:0xf
  v_mov_b32_dpp v147, v133 row_newbcast:14 row_mask:0xf bank_mask:0xf
  v_max_f32 v140, v136, v137
  v_max_f32 v148, v144, v145
  s_nop 1
  v_permlane32_swap_b32 v140, v148
  v_max_f32 v152, v140, v148
  v_mov_b32 v153, v152
  s_nop 1
  v_permlane16_swap_b32 v152, v153
  v_max_f32 v152, v152, v153
  v_mov_b32 v140, v152
  v_mov_b32 v148, v152
  s_nop 1
  v_permlane32_swap_b32 v140, v148
  v_sub_f32 v136, v136, v140
  v_sub_f32 v137, v137, v140
  v_sub_f32 v144, v144, v148
  v_sub_f32 v145, v145, v148
  v_exp_f32 v136, v136
  v_exp_f32 v137, v137
  v_exp_f32 v144, v144
  v_exp_f32 v145, v145
  v_mul_f32 v143, v138, v136
  v_cndmask_b32 v142, v137, v136, s[56:57]
  v_mul_f32 v151, v146, v144
  v_cndmask_b32 v150, v145, v144, s[56:57]
  v_fmac_f32 v143, v139, v137
  v_mul_f32 v128, v128, v142
  v_mul_f32 v129, v129, v142
  v_mul_f32 v130, v130, v142
  v_mul_f32 v131, v131, v142
  v_fmac_f32 v151, v147, v145
  v_mul_f32 v132, v132, v150
  v_mul_f32 v133, v133, v150
  v_mul_f32 v134, v134, v150
  v_mul_f32 v135, v135, v150
  v_permlane32_swap_b32 v128, v132
  v_permlane32_swap_b32 v129, v133
  v_permlane32_swap_b32 v130, v134
  v_permlane32_swap_b32 v131, v135
  v_permlane32_swap_b32 v143, v151
  v_add_f32 v128, v128, v132
  v_add_f32 v129, v129, v133
  v_add_f32 v130, v130, v134
  v_add_f32 v131, v131, v135
  v_add_f32 v153, v143, v151
  v_permlane16_swap_b32 v128, v129
  v_permlane16_swap_b32 v130, v131
  v_mov_b32 v154, v153
  v_add_f32 v128, v128, v129
  v_add_f32 v130, v130, v131
  v_permlane16_swap_b32 v153, v154
  v_add_f32_dpp v128, v128, v128 row_ror:8 row_mask:0xf bank_mask:0xf
  v_add_f32_dpp v130, v130, v130 row_ror:8 row_mask:0xf bank_mask:0xf
  v_add_f32 v153, v153, v154
  v_rcp_f32 v153, v153
  s_nop 0
  v_mul_f32 v128, v128, v153
  v_mul_f32 v130, v130, v153
  v_cvt_pk_bf16_f32 v128, v128, v128
  v_cvt_pk_bf16_f32 v130, v130, v130
  s_mov_b32 s46, 0x003f003f
  s_mov_b32 s47, 0x003f003f
  s_mov_b64 exec, s[46:47]
  ds_write_b16 v240, v128 offset:15232
  ds_write_b16 v240, v130 offset:15236
  s_mov_b64 exec, -1
  s_waitcnt lgkmcnt(0)
  s_branch L_ob_wait
L_wo_perm:
  s_mov_b32 s46, 0x05040100
  s_mov_b32 s47, 0x07060302
  s_waitcnt vmcnt(22)
  v_perm_b32 v72, v194, v192, s46
  v_perm_b32 v73, v194, v192, s47
  v_perm_b32 v74, v195, v193, s46
  v_perm_b32 v75, v195, v193, s47
  s_waitcnt vmcnt(20)
  v_perm_b32 v76, v198, v196, s46
  v_perm_b32 v77, v198, v196, s47
  v_perm_b32 v78, v199, v197, s46
  v_perm_b32 v79, v199, v197, s47
  s_waitcnt vmcnt(18)
  v_perm_b32 v80, v202, v200, s46
  v_perm_b32 v81, v202, v200, s47
  v_perm_b32 v82, v203, v201, s46
  v_perm_b32 v83, v203, v201, s47
  s_waitcnt vmcnt(16)
  v_perm_b32 v84, v206, v204, s46
  v_perm_b32 v85, v206, v204, s47
  v_perm_b32 v86, v207, v205, s46
  v_perm_b32 v87, v207, v205, s47
  s_waitcnt vmcnt(14)
  v_perm_b32 v88, v210, v208, s46
  v_perm_b32 v89, v210, v208, s47
  v_perm_b32 v90, v211, v209, s46
  v_perm_b32 v91, v211, v209, s47
  s_waitcnt vmcnt(12)
  v_perm_b32 v92, v214, v212, s46
  v_perm_b32 v93, v214, v212, s47
  v_perm_b32 v94, v215, v213, s46
  v_perm_b32 v95, v215, v213, s47
  s_waitcnt vmcnt(10)
  v_perm_b32 v96, v218, v216, s46
  v_perm_b32 v97, v218, v216, s47
  v_perm_b32 v98, v219, v217, s46
  v_perm_b32 v99, v219, v217, s47
  s_waitcnt vmcnt(8)
  v_perm_b32 v100, v222, v220, s46
  v_perm_b32 v101, v222, v220, s47
  v_perm_b32 v102, v223, v221, s46
  v_perm_b32 v103, v223, v221, s47
  s_waitcnt vmcnt(6)
  v_perm_b32 v104, v226, v224, s46
  v_perm_b32 v105, v226, v224, s47
  v_perm_b32 v106, v227, v225, s46
  v_perm_b32 v107, v227, v225, s47
  s_waitcnt vmcnt(4)
  v_perm_b32 v108, v230, v228, s46
  v_perm_b32 v109, v230, v228, s47
  v_perm_b32 v110, v231, v229, s46
  v_perm_b32 v111, v231, v229, s47
  s_waitcnt vmcnt(2)
  v_perm_b32 v112, v234, v232, s46
  v_perm_b32 v113, v234, v232, s47
  v_perm_b32 v114, v235, v233, s46
  v_perm_b32 v115, v235, v233, s47
  s_waitcnt vmcnt(0)
  v_perm_b32 v116, v238, v236, s46
  v_perm_b32 v117, v238, v236, s47
  v_perm_b32 v118, v239, v237, s46
  v_perm_b32 v119, v239, v237, s47
  s_nop 1
L_ob_wait:
  s_barrier
  s_cmp_eq_u32 s35, 0
  s_cbranch_scc1 L_y_done
  v_mov_b32 v3, 0
  ds_read_b128 v[128:131], v3 offset:15232
  ds_read_b128 v[132:135], v3 offset:15248
  ds_read_b128 v[136:139], v3 offset:15264
  ds_read_b128 v[140:143], v3 offset:15280
  ds_read_b128 v[144:147], v3 offset:15296
  ds_read_b128 v[148:151], v3 offset:15312
  v_mov_b32 v160, 0
  v_mov_b32 v161, 0
  v_mov_b32 v162, 0
  v_mov_b32 v163, 0
  v_mov_b32 v164, 0
  v_mov_b32 v165, 0
  v_mov_b32 v166, 0
  v_mov_b32 v167, 0
  v_lshlrev_b32 v2, 5, v0
  s_mul_i32 s46, s2, 5120
  s_mul_i32 s47, s35, 1728
  s_sub_u32 s47, s47, 1728
  s_add_u32 s46, s46, s47
  s_add_u32 s46, s46, 524288
  s_waitcnt lgkmcnt(3)
  v_dot2c_f32_bf16 v160, v72, v128
  v_dot2c_f32_bf16 v161, v73, v128
  v_dot2c_f32_bf16 v164, v74, v128
  v_dot2c_f32_bf16 v165, v75, v128
  v_dot2c_f32_bf16 v160, v76, v129
  v_dot2c_f32_bf16 v161, v77, v129
  v_dot2c_f32_bf16 v164, v78, v129
  v_dot2c_f32_bf16 v165, v79, v129
  v_dot2c_f32_bf16 v160, v80, v130
  v_dot2c_f32_bf16 v161, v81, v130
  v_dot2c_f32_bf16 v164, v82, v130
  v_dot2c_f32_bf16 v165, v83, v130
  v_dot2c_f32_bf16 v160, v84, v131
  v_dot2c_f32_bf16 v161, v85, v131
  v_dot2c_f32_bf16 v164, v86, v131
  v_dot2c_f32_bf16 v165, v87, v131
  v_dot2c_f32_bf16 v160, v88, v132
  v_dot2c_f32_bf16 v161, v89, v132
  v_dot2c_f32_bf16 v164, v90, v132
  v_dot2c_f32_bf16 v165, v91, v132
  v_dot2c_f32_bf16 v160, v92, v133
  v_dot2c_f32_bf16 v161, v93, v133
  v_dot2c_f32_bf16 v164, v94, v133
  v_dot2c_f32_bf16 v165, v95, v133
  v_dot2c_f32_bf16 v160, v96, v134
  v_dot2c_f32_bf16 v161, v97, v134
  v_dot2c_f32_bf16 v164, v98, v134
  v_dot2c_f32_bf16 v165, v99, v134
  v_dot2c_f32_bf16 v160, v100, v135
  v_dot2c_f32_bf16 v161, v101, v135
  v_dot2c_f32_bf16 v164, v102, v135
  v_dot2c_f32_bf16 v165, v103, v135
  v_dot2c_f32_bf16 v160, v104, v136
  v_dot2c_f32_bf16 v161, v105, v136
  v_dot2c_f32_bf16 v164, v106, v136
  v_dot2c_f32_bf16 v165, v107, v136
  v_dot2c_f32_bf16 v160, v108, v137
  v_dot2c_f32_bf16 v161, v109, v137
  v_dot2c_f32_bf16 v164, v110, v137
  v_dot2c_f32_bf16 v165, v111, v137
  v_dot2c_f32_bf16 v160, v112, v138
  v_dot2c_f32_bf16 v161, v113, v138
  v_dot2c_f32_bf16 v164, v114, v138
  v_dot2c_f32_bf16 v165, v115, v138
  v_dot2c_f32_bf16 v160, v116, v139
  v_dot2c_f32_bf16 v161, v117, v139
  v_dot2c_f32_bf16 v164, v118, v139
  v_dot2c_f32_bf16 v165, v119, v139
  s_waitcnt lgkmcnt(0)
  v_dot2c_f32_bf16 v162, v72, v140
  v_dot2c_f32_bf16 v163, v73, v140
  v_dot2c_f32_bf16 v166, v74, v140
  v_dot2c_f32_bf16 v167, v75, v140
  v_dot2c_f32_bf16 v162, v76, v141
  v_dot2c_f32_bf16 v163, v77, v141
  v_dot2c_f32_bf16 v166, v78, v141
  v_dot2c_f32_bf16 v167, v79, v141
  v_dot2c_f32_bf16 v162, v80, v142
  v_dot2c_f32_bf16 v163, v81, v142
  v_dot2c_f32_bf16 v166, v82, v142
  v_dot2c_f32_bf16 v167, v83, v142
  v_dot2c_f32_bf16 v162, v84, v143
  v_dot2c_f32_bf16 v163, v85, v143
  v_dot2c_f32_bf16 v166, v86, v143
  v_dot2c_f32_bf16 v167, v87, v143
  v_dot2c_f32_bf16 v162, v88, v144
  v_dot2c_f32_bf16 v163, v89, v144
  v_dot2c_f32_bf16 v166, v90, v144
  v_dot2c_f32_bf16 v167, v91, v144
  v_dot2c_f32_bf16 v162, v92, v145
  v_dot2c_f32_bf16 v163, v93, v145
  v_dot2c_f32_bf16 v166, v94, v145
  v_dot2c_f32_bf16 v167, v95, v145
  v_dot2c_f32_bf16 v162, v96, v146
  v_dot2c_f32_bf16 v163, v97, v146
  v_dot2c_f32_bf16 v166, v98, v146
  v_dot2c_f32_bf16 v167, v99, v146
  v_dot2c_f32_bf16 v162, v100, v147
  v_dot2c_f32_bf16 v163, v101, v147
  v_dot2c_f32_bf16 v166, v102, v147
  v_dot2c_f32_bf16 v167, v103, v147
  v_dot2c_f32_bf16 v162, v104, v148
  v_dot2c_f32_bf16 v163, v105, v148
  v_dot2c_f32_bf16 v166, v106, v148
  v_dot2c_f32_bf16 v167, v107, v148
  v_dot2c_f32_bf16 v162, v108, v149
  v_dot2c_f32_bf16 v163, v109, v149
  v_dot2c_f32_bf16 v166, v110, v149
  v_dot2c_f32_bf16 v167, v111, v149
  v_dot2c_f32_bf16 v162, v112, v150
  v_dot2c_f32_bf16 v163, v113, v150
  v_dot2c_f32_bf16 v166, v114, v150
  v_dot2c_f32_bf16 v167, v115, v150
  v_dot2c_f32_bf16 v162, v116, v151
  v_dot2c_f32_bf16 v163, v117, v151
  v_dot2c_f32_bf16 v166, v118, v151
  v_dot2c_f32_bf16 v167, v119, v151
  s_cmp_eq_u32 s35, 3
  s_cselect_b32 s59, 2, 0
  s_lshr_b32 exec_hi, 0x3fffff, s59
  buffer_store_dwordx4 v[160:163], v2, s[48:51], s46 offen sc1
  buffer_store_dwordx4 v[164:167], v2, s[48:51], s46 offen offset:16 sc1
  s_mov_b64 exec, -1
  s_nop 0
L_y_done:
  s_cmp_ge_u32 s2, 40
  s_cbranch_scc1 L_fin
  v_lshrrev_b32 v3, 3, v0
  s_lshl_b32 s46, s35, 3
  v_add_u32 v3, s46, v3
  v_mul_u32_u24 v3, 5120, v3
  v_and_b32 v4, 7, v0
  v_lshl_add_u32 v3, v4, 4, v3
  s_lshl_b32 s47, s2, 7
  s_add_u32 s47, s47, 524288
  s_lshl_b32 s46, s35, 8
  v_add_u32 v5, s46, v1
  s_mov_b32 s36, s22
  s_mov_b32 s37, s23
  s_mov_b32 s38, 2560
  s_mov_b32 s39, 0x20000
  s_mov_b32 s58, 262144
L_h2_poll:
  s_mov_b32 s46, s47
  buffer_load_dwordx4 v[128:131], v3, s[48:51], s46 offen sc1
  s_add_u32 s46, s46, 163840
  buffer_load_dwordx4 v[132:135], v3, s[48:51], s46 offen sc1
  s_add_u32 s46, s46, 163840
  buffer_load_dwordx4 v[136:139], v3, s[48:51], s46 offen sc1
  s_add_u32 s46, s46, 163840
  buffer_load_dwordx4 v[140:143], v3, s[48:51], s46 offen sc1
  s_add_u32 s46, s46, 163840
  buffer_load_dwordx4 v[144:147], v3, s[48:51], s46 offen sc1
  s_add_u32 s46, s46, 163840
  buffer_load_dwordx4 v[148:151], v3, s[48:51], s46 offen sc1
  s_add_u32 s46, s46, 163840
  buffer_load_dwordx4 v[152:155], v3, s[48:51], s46 offen sc1
  s_add_u32 s46, s46, 163840
  buffer_load_dwordx4 v[156:159], v3, s[48:51], s46 offen sc1
  s_add_u32 s46, s46, 163840
  s_waitcnt vmcnt(0)
  v_max3_u32 v6, v128, v129, v130
  v_max3_u32 v6, v6, v131, v132
  v_max3_u32 v6, v6, v133, v134
  v_max3_u32 v6, v6, v135, v136
  v_max3_u32 v6, v6, v137, v138
  v_max3_u32 v6, v6, v139, v140
  v_max3_u32 v6, v6, v141, v142
  v_max3_u32 v6, v6, v143, v144
  v_max3_u32 v6, v6, v145, v146
  v_max3_u32 v6, v6, v147, v148
  v_max3_u32 v6, v6, v149, v150
  v_max3_u32 v6, v6, v151, v152
  v_max3_u32 v6, v6, v153, v154
  v_max3_u32 v6, v6, v155, v156
  v_max3_u32 v6, v6, v157, v158
  v_max_u32 v6, v6, v159
  v_cmp_ne_u32 vcc, -1, v6
  s_nop 0
  s_cmp_eq_u64 vcc, exec
  s_nop 1
  s_cbranch_scc1 L_h2_ok
  s_sub_u32 s58, s58, 1
  s_cmp_eq_u32 s58, 0
  s_cbranch_scc1 L_h2_ok
  s_branch L_h2_poll
L_h2_ok:
  v_add_f32 v128, v128, v132
  v_add_f32 v136, v136, v140
  v_add_f32 v144, v144, v148
  v_add_f32 v152, v152, v156
  v_add_f32 v129, v129, v133
  v_add_f32 v137, v137, v141
  v_add_f32 v145, v145, v149
  v_add_f32 v153, v153, v157
  v_add_f32 v130, v130, v134
  v_add_f32 v138, v138, v142
  v_add_f32 v146, v146, v150
  v_add_f32 v154, v154, v158
  v_add_f32 v131, v131, v135
  v_add_f32 v139, v139, v143
  v_add_f32 v147, v147, v151
  v_add_f32 v155, v155, v159
  v_add_f32 v128, v128, v136
  v_add_f32 v144, v144, v152
  v_add_f32 v129, v129, v137
  v_add_f32 v145, v145, v153
  v_add_f32 v130, v130, v138
  v_add_f32 v146, v146, v154
  v_add_f32 v131, v131, v139
  v_add_f32 v147, v147, v155
  v_add_f32 v128, v128, v144
  v_add_f32 v129, v129, v145
  v_add_f32 v130, v130, v146
  v_add_f32 v131, v131, v147
  v_add_f32_dpp v128, v128, v128 row_ror:8 row_mask:0xf bank_mask:0xf
  v_add_f32_dpp v129, v129, v129 row_ror:8 row_mask:0xf bank_mask:0xf
  v_add_f32_dpp v130, v130, v130 row_ror:8 row_mask:0xf bank_mask:0xf
  v_add_f32_dpp v131, v131, v131 row_ror:8 row_mask:0xf bank_mask:0xf
  s_nop 0
  v_permlane32_swap_b32 v128, v130
  v_permlane32_swap_b32 v129, v131
  v_add_f32 v128, v128, v130
  v_add_f32 v129, v129, v131
  s_nop 1
  v_permlane16_swap_b32 v128, v129
  v_add_f32 v128, v128, v129
  ds_write_b32 v5, v128 offset:17152
  s_waitcnt lgkmcnt(0)
  s_barrier
  s_cmp_lg_u32 s35, 0
  s_cbranch_scc1 L_fin
  ds_read_b32 v128, v1 offset:17152
  ds_read_b32 v129, v1 offset:17408
  ds_read_b32 v130, v1 offset:17664
  ds_read_b32 v131, v1 offset:17920
  v_lshlrev_b32 v248, 16, v248
  s_lshl_b32 s46, s2, 5
  s_mov_b32 s60, 0x00ff00ff
  s_mov_b32 s61, 0x00ff00ff
  s_waitcnt lgkmcnt(0)
  v_add_f32 v128, v128, v129
  v_add_f32 v130, v130, v131
  v_add_f32 v128, v128, v130
  v_cvt_pk_bf16_f32 v128, v128, v128
  v_and_b32 v128, 0xffff0000, v128
  v_mul_f32 v128, v128, v244
  v_cvt_pk_bf16_f32 v128, v128, v128
  v_and_b32 v128, 0xffff0000, v128
  v_add_f32 v128, v128, v248
  v_cvt_pk_bf16_f32 v128, v128, v128
  s_mov_b64 exec, s[60:61]
  buffer_store_short v128, v245, s[36:39], s46 offen
  s_mov_b64 exec, -1
L_fin:
  s_branch L_end
L_stream_rest:
  s_mov_b32 s48, s26
  s_mov_b32 s49, s27
  s_mov_b32 s50, 8388608
  s_mov_b32 s51, 0x20000
  s_waitcnt vmcnt(0)
  buffer_load_dwordx4 v[80:83], v1, s[40:43], s44 offen offset:0 nt
  buffer_load_dwordx4 v[84:87], v1, s[40:43], s44 offen offset:128 nt
  buffer_load_dwordx4 v[88:91], v1, s[40:43], s44 offen offset:256 nt
  buffer_load_dwordx4 v[92:95], v1, s[40:43], s44 offen offset:3072 nt
  buffer_load_dwordx4 v[96:99], v1, s[40:43], s44 offen offset:3200 nt
  buffer_load_dwordx4 v[100:103], v1, s[40:43], s44 offen offset:3328 nt
  s_add_u32 s44, s44, 196608
  s_cmp_ge_u32 s44, s56
  s_cselect_b32 s46, 6291456, 0
  s_sub_u32 s44, s44, s46
  s_waitcnt vmcnt(0)
  buffer_load_dwordx4 v[104:107], v1, s[36:39], s44 offen offset:0 nt
  buffer_load_dwordx4 v[108:111], v1, s[36:39], s44 offen offset:128 nt
  buffer_load_dwordx4 v[112:115], v1, s[36:39], s44 offen offset:256 nt
  buffer_load_dwordx4 v[116:119], v1, s[36:39], s44 offen offset:3072 nt
  buffer_load_dwordx4 v[120:123], v1, s[36:39], s44 offen offset:3200 nt
  buffer_load_dwordx4 v[124:127], v1, s[36:39], s44 offen offset:3328 nt
  s_waitcnt vmcnt(0)
  buffer_load_dwordx4 v[128:131], v1, s[40:43], s44 offen offset:0 nt
  buffer_load_dwordx4 v[132:135], v1, s[40:43], s44 offen offset:128 nt
  buffer_load_dwordx4 v[136:139], v1, s[40:43], s44 offen offset:256 nt
  buffer_load_dwordx4 v[140:143], v1, s[40:43], s44 offen offset:3072 nt
  buffer_load_dwordx4 v[144:147], v1, s[40:43], s44 offen offset:3200 nt
  buffer_load_dwordx4 v[148:151], v1, s[40:43], s44 offen offset:3328 nt
  s_add_u32 s44, s44, 196608
  s_cmp_ge_u32 s44, s56
  s_cselect_b32 s46, 6291456, 0
  s_sub_u32 s44, s44, s46
  s_waitcnt vmcnt(0)
  buffer_load_dwordx4 v[152:155], v1, s[36:39], s44 offen offset:0 nt
  buffer_load_dwordx4 v[156:159], v1, s[36:39], s44 offen offset:128 nt
  buffer_load_dwordx4 v[160:163], v1, s[36:39], s44 offen offset:256 nt
  buffer_load_dwordx4 v[164:167], v1, s[36:39], s44 offen offset:3072 nt
  buffer_load_dwordx4 v[168:171], v1, s[36:39], s44 offen offset:3200 nt
  buffer_load_dwordx4 v[172:175], v1, s[36:39], s44 offen offset:3328 nt
  s_waitcnt vmcnt(0)
  buffer_load_dwordx4 v[176:179], v1, s[40:43], s44 offen offset:0 nt
  buffer_load_dwordx4 v[180:183], v1, s[40:43], s44 offen offset:128 nt
  buffer_load_dwordx4 v[184:187], v1, s[40:43], s44 offen offset:256 nt
  buffer_load_dwordx4 v[188:191], v1, s[40:43], s44 offen offset:3072 nt
  buffer_load_dwordx4 v[192:195], v1, s[40:43], s44 offen offset:3200 nt
  buffer_load_dwordx4 v[196:199], v1, s[40:43], s44 offen offset:3328 nt
  s_add_u32 s44, s44, 196608
  s_cmp_ge_u32 s44, s56
  s_cselect_b32 s46, 6291456, 0
  s_sub_u32 s44, s44, s46
  s_waitcnt vmcnt(0)
  buffer_load_dwordx4 v[200:203], v1, s[36:39], s44 offen offset:0 nt
  buffer_load_dwordx4 v[204:207], v1, s[36:39], s44 offen offset:128 nt
  buffer_load_dwordx4 v[208:211], v1, s[36:39], s44 offen offset:256 nt
  buffer_load_dwordx4 v[212:215], v1, s[36:39], s44 offen offset:3072 nt
  buffer_load_dwordx4 v[216:219], v1, s[36:39], s44 offen offset:3200 nt
  buffer_load_dwordx4 v[220:223], v1, s[36:39], s44 offen offset:3328 nt
  s_waitcnt vmcnt(0)
  buffer_load_dwordx4 v[224:227], v1, s[40:43], s44 offen offset:0 nt
  buffer_load_dwordx4 v[228:231], v1, s[40:43], s44 offen offset:128 nt
  buffer_load_dwordx4 v[232:235], v1, s[40:43], s44 offen offset:256 nt
  buffer_load_dwordx4 v[236:239], v1, s[40:43], s44 offen offset:3072 nt
  buffer_load_dwordx4 v[240:243], v1, s[40:43], s44 offen offset:3200 nt
  buffer_load_dwordx4 v[244:247], v1, s[40:43], s44 offen offset:3328 nt
  s_add_u32 s44, s44, 196608
  s_cmp_ge_u32 s44, s56
  s_cselect_b32 s46, 6291456, 0
  s_sub_u32 s44, s44, s46
  v_mov_b32 v16, 0
  v_mov_b32 v17, 0
  v_mov_b32 v18, 0
  v_mov_b32 v19, 0
  v_mov_b32 v20, 0
  v_mov_b32 v21, 0
  v_mov_b32 v22, 0
  v_mov_b32 v23, 0
  v_mov_b32 v24, 0
  v_mov_b32 v25, 0
  v_mov_b32 v26, 0
  v_mov_b32 v27, 0
  v_mov_b32 v28, 0
  v_mov_b32 v29, 0
  v_mov_b32 v30, 0
  v_mov_b32 v31, 0
  v_mov_b32 v32, 0
  v_mov_b32 v33, 0
  v_mov_b32 v34, 0
  v_mov_b32 v35, 0
  v_mov_b32 v36, 0
  v_mov_b32 v37, 0
  v_mov_b32 v38, 0
  v_mov_b32 v39, 0
  v_mov_b32 v40, 0xf149f2ca
  v_mov_b32 v41, 0
  s_barrier
  v_and_b32 v2, 7, v0
  v_mul_u32_u24 v2, 48, v2
  ds_read_b128 v[4:7], v2 offset:8192
  ds_read_b128 v[8:11], v2 offset:8208
  ds_read_b128 v[12:15], v2 offset:8224
  s_waitcnt lgkmcnt(0)
  v_mov_b32 v42, 0
  v_mov_b32 v43, 0
  v_dot2c_f32_bf16 v42, v56, v4
  v_dot2c_f32_bf16 v43, v68, v4
  v_dot2c_f32_bf16 v42, v57, v5
  v_dot2c_f32_bf16 v43, v69, v5
  v_dot2c_f32_bf16 v42, v58, v6
  v_dot2c_f32_bf16 v43, v70, v6
  v_dot2c_f32_bf16 v42, v59, v7
  v_dot2c_f32_bf16 v43, v71, v7
  v_dot2c_f32_bf16 v42, v60, v8
  v_dot2c_f32_bf16 v43, v72, v8
  v_dot2c_f32_bf16 v42, v61, v9
  v_dot2c_f32_bf16 v43, v73, v9
  v_dot2c_f32_bf16 v42, v62, v10
  v_dot2c_f32_bf16 v43, v74, v10
  v_dot2c_f32_bf16 v42, v63, v11
  v_dot2c_f32_bf16 v43, v75, v11
  v_dot2c_f32_bf16 v42, v64, v12
  v_dot2c_f32_bf16 v43, v76, v12
  v_dot2c_f32_bf16 v42, v65, v13
  v_dot2c_f32_bf16 v43, v77, v13
  v_dot2c_f32_bf16 v42, v66, v14
  v_dot2c_f32_bf16 v43, v78, v14
  v_dot2c_f32_bf16 v42, v67, v15
  v_dot2c_f32_bf16 v43, v79, v15
  buffer_load_dwordx4 v[56:59], v1, s[36:39], s44 offen offset:0 nt
  buffer_load_dwordx4 v[60:63], v1, s[36:39], s44 offen offset:128 nt
  buffer_load_dwordx4 v[64:67], v1, s[36:39], s44 offen offset:256 nt
  buffer_load_dwordx4 v[68:71], v1, s[36:39], s44 offen offset:3072 nt
  buffer_load_dwordx4 v[72:75], v1, s[36:39], s44 offen offset:3200 nt
  buffer_load_dwordx4 v[76:79], v1, s[36:39], s44 offen offset:3328 nt
  v_add_f32_dpp v42, v42, v42 quad_perm:[1,0,3,2] row_mask:0xf bank_mask:0xf
  v_add_f32_dpp v43, v43, v43 quad_perm:[1,0,3,2] row_mask:0xf bank_mask:0xf
  s_nop 0
  v_add_f32_dpp v42, v42, v42 quad_perm:[2,3,0,1] row_mask:0xf bank_mask:0xf
  v_add_f32_dpp v43, v43, v43 quad_perm:[2,3,0,1] row_mask:0xf bank_mask:0xf
  s_nop 0
  v_add_f32_dpp v42, v42, v42 row_half_mirror row_mask:0xf bank_mask:0xf
  v_add_f32_dpp v43, v43, v43 row_half_mirror row_mask:0xf bank_mask:0xf
  v_cvt_pk_bf16_f32 v54, v42, v43
  v_lshlrev_b32 v42, 16, v54
  v_and_b32 v43, 0xffff0000, v54
  v_mul_f32 v42, s33, v42
  v_mul_f32 v43, s33, v43
  v_cvt_pk_bf16_f32 v54, v42, v43
  v_lshlrev_b32 v42, 16, v54
  v_and_b32 v43, 0xffff0000, v54
  v_mul_f32 v44, s34, v42
  v_mul_f32 v45, s34, v43
  v_max3_f32 v46, v40, v44, v45
  v_sub_f32 v48, v40, v46
  v_sub_f32 v44, v44, v46
  v_sub_f32 v45, v45, v46
  v_exp_f32 v48, v48
  v_exp_f32 v44, v44
  v_exp_f32 v45, v45
  v_mov_b32 v40, v46
  v_cvt_pk_bf16_f32 v54, v44, v45
  v_fma_f32 v41, v41, v48, v44
  v_and_b32 v50, 0xffff, v54
  v_lshlrev_b32 v51, 16, v54
  v_lshrrev_b32 v52, 16, v54
  v_and_b32 v53, 0xffff0000, v54
  v_add_f32 v41, v41, v45
  v_pk_mul_f32 v[16:17], v[16:17], v[48:49] op_sel_hi:[1,0]
  v_pk_mul_f32 v[18:19], v[18:19], v[48:49] op_sel_hi:[1,0]
  v_pk_mul_f32 v[20:21], v[20:21], v[48:49] op_sel_hi:[1,0]
  v_pk_mul_f32 v[22:23], v[22:23], v[48:49] op_sel_hi:[1,0]
  v_pk_mul_f32 v[24:25], v[24:25], v[48:49] op_sel_hi:[1,0]
  v_pk_mul_f32 v[26:27], v[26:27], v[48:49] op_sel_hi:[1,0]
  v_pk_mul_f32 v[28:29], v[28:29], v[48:49] op_sel_hi:[1,0]
  v_pk_mul_f32 v[30:31], v[30:31], v[48:49] op_sel_hi:[1,0]
  v_pk_mul_f32 v[32:33], v[32:33], v[48:49] op_sel_hi:[1,0]
  v_pk_mul_f32 v[34:35], v[34:35], v[48:49] op_sel_hi:[1,0]
  v_pk_mul_f32 v[36:37], v[36:37], v[48:49] op_sel_hi:[1,0]
  v_pk_mul_f32 v[38:39], v[38:39], v[48:49] op_sel_hi:[1,0]
  v_dot2c_f32_bf16 v16, v80, v50
  v_dot2c_f32_bf16 v17, v80, v51
  v_dot2c_f32_bf16 v18, v81, v50
  v_dot2c_f32_bf16 v19, v81, v51
  v_dot2c_f32_bf16 v20, v82, v50
  v_dot2c_f32_bf16 v21, v82, v51
  v_dot2c_f32_bf16 v22, v83, v50
  v_dot2c_f32_bf16 v23, v83, v51
  v_dot2c_f32_bf16 v24, v84, v50
  v_dot2c_f32_bf16 v25, v84, v51
  v_dot2c_f32_bf16 v26, v85, v50
  v_dot2c_f32_bf16 v27, v85, v51
  v_dot2c_f32_bf16 v28, v86, v50
  v_dot2c_f32_bf16 v29, v86, v51
  v_dot2c_f32_bf16 v30, v87, v50
  v_dot2c_f32_bf16 v31, v87, v51
  v_dot2c_f32_bf16 v32, v88, v50
  v_dot2c_f32_bf16 v33, v88, v51
  v_dot2c_f32_bf16 v34, v89, v50
  v_dot2c_f32_bf16 v35, v89, v51
  v_dot2c_f32_bf16 v36, v90, v50
  v_dot2c_f32_bf16 v37, v90, v51
  v_dot2c_f32_bf16 v38, v91, v50
  v_dot2c_f32_bf16 v39, v91, v51
  v_dot2c_f32_bf16 v16, v92, v52
  v_dot2c_f32_bf16 v17, v92, v53
  v_dot2c_f32_bf16 v18, v93, v52
  v_dot2c_f32_bf16 v19, v93, v53
  v_dot2c_f32_bf16 v20, v94, v52
  v_dot2c_f32_bf16 v21, v94, v53
  v_dot2c_f32_bf16 v22, v95, v52
  v_dot2c_f32_bf16 v23, v95, v53
  v_dot2c_f32_bf16 v24, v96, v52
  v_dot2c_f32_bf16 v25, v96, v53
  v_dot2c_f32_bf16 v26, v97, v52
  v_dot2c_f32_bf16 v27, v97, v53
  v_dot2c_f32_bf16 v28, v98, v52
  v_dot2c_f32_bf16 v29, v98, v53
  v_dot2c_f32_bf16 v30, v99, v52
  v_dot2c_f32_bf16 v31, v99, v53
  v_dot2c_f32_bf16 v32, v100, v52
  v_dot2c_f32_bf16 v33, v100, v53
  v_dot2c_f32_bf16 v34, v101, v52
  v_dot2c_f32_bf16 v35, v101, v53
  v_dot2c_f32_bf16 v36, v102, v52
  v_dot2c_f32_bf16 v37, v102, v53
  v_dot2c_f32_bf16 v38, v103, v52
  v_dot2c_f32_bf16 v39, v103, v53
  v_mov_b32 v42, 0
  v_mov_b32 v43, 0
  v_dot2c_f32_bf16 v42, v104, v4
  v_dot2c_f32_bf16 v43, v116, v4
  v_dot2c_f32_bf16 v42, v105, v5
  v_dot2c_f32_bf16 v43, v117, v5
  v_dot2c_f32_bf16 v42, v106, v6
  v_dot2c_f32_bf16 v43, v118, v6
  v_dot2c_f32_bf16 v42, v107, v7
  v_dot2c_f32_bf16 v43, v119, v7
  v_dot2c_f32_bf16 v42, v108, v8
  v_dot2c_f32_bf16 v43, v120, v8
  v_dot2c_f32_bf16 v42, v109, v9
  v_dot2c_f32_bf16 v43, v121, v9
  v_dot2c_f32_bf16 v42, v110, v10
  v_dot2c_f32_bf16 v43, v122, v10
  v_dot2c_f32_bf16 v42, v111, v11
  v_dot2c_f32_bf16 v43, v123, v11
  v_dot2c_f32_bf16 v42, v112, v12
  v_dot2c_f32_bf16 v43, v124, v12
  v_dot2c_f32_bf16 v42, v113, v13
  v_dot2c_f32_bf16 v43, v125, v13
  v_dot2c_f32_bf16 v42, v114, v14
  v_dot2c_f32_bf16 v43, v126, v14
  v_dot2c_f32_bf16 v42, v115, v15
  v_dot2c_f32_bf16 v43, v127, v15
  s_nop 1
  v_add_f32_dpp v42, v42, v42 quad_perm:[1,0,3,2] row_mask:0xf bank_mask:0xf
  v_add_f32_dpp v43, v43, v43 quad_perm:[1,0,3,2] row_mask:0xf bank_mask:0xf
  s_nop 0
  v_add_f32_dpp v42, v42, v42 quad_perm:[2,3,0,1] row_mask:0xf bank_mask:0xf
  v_add_f32_dpp v43, v43, v43 quad_perm:[2,3,0,1] row_mask:0xf bank_mask:0xf
  s_nop 0
  v_add_f32_dpp v42, v42, v42 row_half_mirror row_mask:0xf bank_mask:0xf
  v_add_f32_dpp v43, v43, v43 row_half_mirror row_mask:0xf bank_mask:0xf
  v_cvt_pk_bf16_f32 v54, v42, v43
  v_lshlrev_b32 v42, 16, v54
  v_and_b32 v43, 0xffff0000, v54
  v_mul_f32 v42, s33, v42
  v_mul_f32 v43, s33, v43
  v_cvt_pk_bf16_f32 v54, v42, v43
  v_lshlrev_b32 v42, 16, v54
  v_and_b32 v43, 0xffff0000, v54
  v_mul_f32 v44, s34, v42
  v_mul_f32 v45, s34, v43
  v_max3_f32 v46, v40, v44, v45
  v_sub_f32 v48, v40, v46
  v_sub_f32 v44, v44, v46
  v_sub_f32 v45, v45, v46
  v_exp_f32 v48, v48
  v_exp_f32 v44, v44
  v_exp_f32 v45, v45
  v_mov_b32 v40, v46
  v_cvt_pk_bf16_f32 v54, v44, v45
  v_fma_f32 v41, v41, v48, v44
  v_and_b32 v50, 0xffff, v54
  v_lshlrev_b32 v51, 16, v54
  v_lshrrev_b32 v52, 16, v54
  v_and_b32 v53, 0xffff0000, v54
  v_add_f32 v41, v41, v45
  v_pk_mul_f32 v[16:17], v[16:17], v[48:49] op_sel_hi:[1,0]
  v_pk_mul_f32 v[18:19], v[18:19], v[48:49] op_sel_hi:[1,0]
  v_pk_mul_f32 v[20:21], v[20:21], v[48:49] op_sel_hi:[1,0]
  v_pk_mul_f32 v[22:23], v[22:23], v[48:49] op_sel_hi:[1,0]
  v_pk_mul_f32 v[24:25], v[24:25], v[48:49] op_sel_hi:[1,0]
  v_pk_mul_f32 v[26:27], v[26:27], v[48:49] op_sel_hi:[1,0]
  v_pk_mul_f32 v[28:29], v[28:29], v[48:49] op_sel_hi:[1,0]
  v_pk_mul_f32 v[30:31], v[30:31], v[48:49] op_sel_hi:[1,0]
  v_pk_mul_f32 v[32:33], v[32:33], v[48:49] op_sel_hi:[1,0]
  v_pk_mul_f32 v[34:35], v[34:35], v[48:49] op_sel_hi:[1,0]
  v_pk_mul_f32 v[36:37], v[36:37], v[48:49] op_sel_hi:[1,0]
  v_pk_mul_f32 v[38:39], v[38:39], v[48:49] op_sel_hi:[1,0]
  v_dot2c_f32_bf16 v16, v128, v50
  v_dot2c_f32_bf16 v17, v128, v51
  v_dot2c_f32_bf16 v18, v129, v50
  v_dot2c_f32_bf16 v19, v129, v51
  v_dot2c_f32_bf16 v20, v130, v50
  v_dot2c_f32_bf16 v21, v130, v51
  v_dot2c_f32_bf16 v22, v131, v50
  v_dot2c_f32_bf16 v23, v131, v51
  v_dot2c_f32_bf16 v24, v132, v50
  v_dot2c_f32_bf16 v25, v132, v51
  v_dot2c_f32_bf16 v26, v133, v50
  v_dot2c_f32_bf16 v27, v133, v51
  v_dot2c_f32_bf16 v28, v134, v50
  v_dot2c_f32_bf16 v29, v134, v51
  v_dot2c_f32_bf16 v30, v135, v50
  v_dot2c_f32_bf16 v31, v135, v51
  v_dot2c_f32_bf16 v32, v136, v50
  v_dot2c_f32_bf16 v33, v136, v51
  v_dot2c_f32_bf16 v34, v137, v50
  v_dot2c_f32_bf16 v35, v137, v51
  v_dot2c_f32_bf16 v36, v138, v50
  v_dot2c_f32_bf16 v37, v138, v51
  v_dot2c_f32_bf16 v38, v139, v50
  v_dot2c_f32_bf16 v39, v139, v51
  v_dot2c_f32_bf16 v16, v140, v52
  v_dot2c_f32_bf16 v17, v140, v53
  v_dot2c_f32_bf16 v18, v141, v52
  v_dot2c_f32_bf16 v19, v141, v53
  v_dot2c_f32_bf16 v20, v142, v52
  v_dot2c_f32_bf16 v21, v142, v53
  v_dot2c_f32_bf16 v22, v143, v52
  v_dot2c_f32_bf16 v23, v143, v53
  v_dot2c_f32_bf16 v24, v144, v52
  v_dot2c_f32_bf16 v25, v144, v53
  v_dot2c_f32_bf16 v26, v145, v52
  v_dot2c_f32_bf16 v27, v145, v53
  v_dot2c_f32_bf16 v28, v146, v52
  v_dot2c_f32_bf16 v29, v146, v53
  v_dot2c_f32_bf16 v30, v147, v52
  v_dot2c_f32_bf16 v31, v147, v53
  v_dot2c_f32_bf16 v32, v148, v52
  v_dot2c_f32_bf16 v33, v148, v53
  v_dot2c_f32_bf16 v34, v149, v52
  v_dot2c_f32_bf16 v35, v149, v53
  v_dot2c_f32_bf16 v36, v150, v52
  v_dot2c_f32_bf16 v37, v150, v53
  v_dot2c_f32_bf16 v38, v151, v52
  v_dot2c_f32_bf16 v39, v151, v53
  v_mov_b32 v42, 0
  v_mov_b32 v43, 0
  v_dot2c_f32_bf16 v42, v152, v4
  v_dot2c_f32_bf16 v43, v164, v4
  v_dot2c_f32_bf16 v42, v153, v5
  v_dot2c_f32_bf16 v43, v165, v5
  v_dot2c_f32_bf16 v42, v154, v6
  v_dot2c_f32_bf16 v43, v166, v6
  v_dot2c_f32_bf16 v42, v155, v7
  v_dot2c_f32_bf16 v43, v167, v7
  v_dot2c_f32_bf16 v42, v156, v8
  v_dot2c_f32_bf16 v43, v168, v8
  v_dot2c_f32_bf16 v42, v157, v9
  v_dot2c_f32_bf16 v43, v169, v9
  v_dot2c_f32_bf16 v42, v158, v10
  v_dot2c_f32_bf16 v43, v170, v10
  v_dot2c_f32_bf16 v42, v159, v11
  v_dot2c_f32_bf16 v43, v171, v11
  v_dot2c_f32_bf16 v42, v160, v12
  v_dot2c_f32_bf16 v43, v172, v12
  v_dot2c_f32_bf16 v42, v161, v13
  v_dot2c_f32_bf16 v43, v173, v13
  v_dot2c_f32_bf16 v42, v162, v14
  v_dot2c_f32_bf16 v43, v174, v14
  v_dot2c_f32_bf16 v42, v163, v15
  v_dot2c_f32_bf16 v43, v175, v15
  s_nop 1
  v_add_f32_dpp v42, v42, v42 quad_perm:[1,0,3,2] row_mask:0xf bank_mask:0xf
  v_add_f32_dpp v43, v43, v43 quad_perm:[1,0,3,2] row_mask:0xf bank_mask:0xf
  s_nop 0
  v_add_f32_dpp v42, v42, v42 quad_perm:[2,3,0,1] row_mask:0xf bank_mask:0xf
  v_add_f32_dpp v43, v43, v43 quad_perm:[2,3,0,1] row_mask:0xf bank_mask:0xf
  s_nop 0
  v_add_f32_dpp v42, v42, v42 row_half_mirror row_mask:0xf bank_mask:0xf
  v_add_f32_dpp v43, v43, v43 row_half_mirror row_mask:0xf bank_mask:0xf
  v_cvt_pk_bf16_f32 v54, v42, v43
  v_lshlrev_b32 v42, 16, v54
  v_and_b32 v43, 0xffff0000, v54
  v_mul_f32 v42, s33, v42
  v_mul_f32 v43, s33, v43
  v_cvt_pk_bf16_f32 v54, v42, v43
  v_lshlrev_b32 v42, 16, v54
  v_and_b32 v43, 0xffff0000, v54
  v_mul_f32 v44, s34, v42
  v_mul_f32 v45, s34, v43
  v_max3_f32 v46, v40, v44, v45
  v_sub_f32 v48, v40, v46
  v_sub_f32 v44, v44, v46
  v_sub_f32 v45, v45, v46
  v_exp_f32 v48, v48
  v_exp_f32 v44, v44
  v_exp_f32 v45, v45
  v_mov_b32 v40, v46
  v_cvt_pk_bf16_f32 v54, v44, v45
  v_fma_f32 v41, v41, v48, v44
  v_and_b32 v50, 0xffff, v54
  v_lshlrev_b32 v51, 16, v54
  v_lshrrev_b32 v52, 16, v54
  v_and_b32 v53, 0xffff0000, v54
  v_add_f32 v41, v41, v45
  v_pk_mul_f32 v[16:17], v[16:17], v[48:49] op_sel_hi:[1,0]
  v_pk_mul_f32 v[18:19], v[18:19], v[48:49] op_sel_hi:[1,0]
  v_pk_mul_f32 v[20:21], v[20:21], v[48:49] op_sel_hi:[1,0]
  v_pk_mul_f32 v[22:23], v[22:23], v[48:49] op_sel_hi:[1,0]
  v_pk_mul_f32 v[24:25], v[24:25], v[48:49] op_sel_hi:[1,0]
  v_pk_mul_f32 v[26:27], v[26:27], v[48:49] op_sel_hi:[1,0]
  v_pk_mul_f32 v[28:29], v[28:29], v[48:49] op_sel_hi:[1,0]
  v_pk_mul_f32 v[30:31], v[30:31], v[48:49] op_sel_hi:[1,0]
  v_pk_mul_f32 v[32:33], v[32:33], v[48:49] op_sel_hi:[1,0]
  v_pk_mul_f32 v[34:35], v[34:35], v[48:49] op_sel_hi:[1,0]
  v_pk_mul_f32 v[36:37], v[36:37], v[48:49] op_sel_hi:[1,0]
  v_pk_mul_f32 v[38:39], v[38:39], v[48:49] op_sel_hi:[1,0]
  v_dot2c_f32_bf16 v16, v176, v50
  v_dot2c_f32_bf16 v17, v176, v51
  v_dot2c_f32_bf16 v18, v177, v50
  v_dot2c_f32_bf16 v19, v177, v51
  v_dot2c_f32_bf16 v20, v178, v50
  v_dot2c_f32_bf16 v21, v178, v51
  v_dot2c_f32_bf16 v22, v179, v50
  v_dot2c_f32_bf16 v23, v179, v51
  v_dot2c_f32_bf16 v24, v180, v50
  v_dot2c_f32_bf16 v25, v180, v51
  v_dot2c_f32_bf16 v26, v181, v50
  v_dot2c_f32_bf16 v27, v181, v51
  v_dot2c_f32_bf16 v28, v182, v50
  v_dot2c_f32_bf16 v29, v182, v51
  v_dot2c_f32_bf16 v30, v183, v50
  v_dot2c_f32_bf16 v31, v183, v51
  v_dot2c_f32_bf16 v32, v184, v50
  v_dot2c_f32_bf16 v33, v184, v51
  v_dot2c_f32_bf16 v34, v185, v50
  v_dot2c_f32_bf16 v35, v185, v51
  v_dot2c_f32_bf16 v36, v186, v50
  v_dot2c_f32_bf16 v37, v186, v51
  v_dot2c_f32_bf16 v38, v187, v50
  v_dot2c_f32_bf16 v39, v187, v51
  v_dot2c_f32_bf16 v16, v188, v52
  v_dot2c_f32_bf16 v17, v188, v53
  v_dot2c_f32_bf16 v18, v189, v52
  v_dot2c_f32_bf16 v19, v189, v53
  v_dot2c_f32_bf16 v20, v190, v52
  v_dot2c_f32_bf16 v21, v190, v53
  v_dot2c_f32_bf16 v22, v191, v52
  v_dot2c_f32_bf16 v23, v191, v53
  v_dot2c_f32_bf16 v24, v192, v52
  v_dot2c_f32_bf16 v25, v192, v53
  v_dot2c_f32_bf16 v26, v193, v52
  v_dot2c_f32_bf16 v27, v193, v53
  v_dot2c_f32_bf16 v28, v194, v52
  v_dot2c_f32_bf16 v29, v194, v53
  v_dot2c_f32_bf16 v30, v195, v52
  v_dot2c_f32_bf16 v31, v195, v53
  v_dot2c_f32_bf16 v32, v196, v52
  v_dot2c_f32_bf16 v33, v196, v53
  v_dot2c_f32_bf16 v34, v197, v52
  v_dot2c_f32_bf16 v35, v197, v53
  v_dot2c_f32_bf16 v36, v198, v52
  v_dot2c_f32_bf16 v37, v198, v53
  v_dot2c_f32_bf16 v38, v199, v52
  v_dot2c_f32_bf16 v39, v199, v53
  v_mov_b32 v42, 0
  v_mov_b32 v43, 0
  v_dot2c_f32_bf16 v42, v200, v4
  v_dot2c_f32_bf16 v43, v212, v4
  v_dot2c_f32_bf16 v42, v201, v5
  v_dot2c_f32_bf16 v43, v213, v5
  v_dot2c_f32_bf16 v42, v202, v6
  v_dot2c_f32_bf16 v43, v214, v6
  v_dot2c_f32_bf16 v42, v203, v7
  v_dot2c_f32_bf16 v43, v215, v7
  v_dot2c_f32_bf16 v42, v204, v8
  v_dot2c_f32_bf16 v43, v216, v8
  v_dot2c_f32_bf16 v42, v205, v9
  v_dot2c_f32_bf16 v43, v217, v9
  v_dot2c_f32_bf16 v42, v206, v10
  v_dot2c_f32_bf16 v43, v218, v10
  v_dot2c_f32_bf16 v42, v207, v11
  v_dot2c_f32_bf16 v43, v219, v11
  v_dot2c_f32_bf16 v42, v208, v12
  v_dot2c_f32_bf16 v43, v220, v12
  v_dot2c_f32_bf16 v42, v209, v13
  v_dot2c_f32_bf16 v43, v221, v13
  v_dot2c_f32_bf16 v42, v210, v14
  v_dot2c_f32_bf16 v43, v222, v14
  v_dot2c_f32_bf16 v42, v211, v15
  v_dot2c_f32_bf16 v43, v223, v15
  s_nop 1
  v_add_f32_dpp v42, v42, v42 quad_perm:[1,0,3,2] row_mask:0xf bank_mask:0xf
  v_add_f32_dpp v43, v43, v43 quad_perm:[1,0,3,2] row_mask:0xf bank_mask:0xf
  s_nop 0
  v_add_f32_dpp v42, v42, v42 quad_perm:[2,3,0,1] row_mask:0xf bank_mask:0xf
  v_add_f32_dpp v43, v43, v43 quad_perm:[2,3,0,1] row_mask:0xf bank_mask:0xf
  s_nop 0
  v_add_f32_dpp v42, v42, v42 row_half_mirror row_mask:0xf bank_mask:0xf
  v_add_f32_dpp v43, v43, v43 row_half_mirror row_mask:0xf bank_mask:0xf
  v_cvt_pk_bf16_f32 v54, v42, v43
  v_lshlrev_b32 v42, 16, v54
  v_and_b32 v43, 0xffff0000, v54
  v_mul_f32 v42, s33, v42
  v_mul_f32 v43, s33, v43
  v_cvt_pk_bf16_f32 v54, v42, v43
  v_lshlrev_b32 v42, 16, v54
  v_and_b32 v43, 0xffff0000, v54
  v_mul_f32 v44, s34, v42
  v_mul_f32 v45, s34, v43
  v_max3_f32 v46, v40, v44, v45
  v_sub_f32 v48, v40, v46
  v_sub_f32 v44, v44, v46
  v_sub_f32 v45, v45, v46
  v_exp_f32 v48, v48
  v_exp_f32 v44, v44
  v_exp_f32 v45, v45
  v_mov_b32 v40, v46
  v_cvt_pk_bf16_f32 v54, v44, v45
  v_fma_f32 v41, v41, v48, v44
  v_and_b32 v50, 0xffff, v54
  v_lshlrev_b32 v51, 16, v54
  v_lshrrev_b32 v52, 16, v54
  v_and_b32 v53, 0xffff0000, v54
  v_add_f32 v41, v41, v45
  v_pk_mul_f32 v[16:17], v[16:17], v[48:49] op_sel_hi:[1,0]
  v_pk_mul_f32 v[18:19], v[18:19], v[48:49] op_sel_hi:[1,0]
  v_pk_mul_f32 v[20:21], v[20:21], v[48:49] op_sel_hi:[1,0]
  v_pk_mul_f32 v[22:23], v[22:23], v[48:49] op_sel_hi:[1,0]
  v_pk_mul_f32 v[24:25], v[24:25], v[48:49] op_sel_hi:[1,0]
  v_pk_mul_f32 v[26:27], v[26:27], v[48:49] op_sel_hi:[1,0]
  v_pk_mul_f32 v[28:29], v[28:29], v[48:49] op_sel_hi:[1,0]
  v_pk_mul_f32 v[30:31], v[30:31], v[48:49] op_sel_hi:[1,0]
  v_pk_mul_f32 v[32:33], v[32:33], v[48:49] op_sel_hi:[1,0]
  v_pk_mul_f32 v[34:35], v[34:35], v[48:49] op_sel_hi:[1,0]
  v_pk_mul_f32 v[36:37], v[36:37], v[48:49] op_sel_hi:[1,0]
  v_pk_mul_f32 v[38:39], v[38:39], v[48:49] op_sel_hi:[1,0]
  s_waitcnt vmcnt(6)
  v_dot2c_f32_bf16 v16, v224, v50
  v_dot2c_f32_bf16 v17, v224, v51
  v_dot2c_f32_bf16 v18, v225, v50
  v_dot2c_f32_bf16 v19, v225, v51
  v_dot2c_f32_bf16 v20, v226, v50
  v_dot2c_f32_bf16 v21, v226, v51
  v_dot2c_f32_bf16 v22, v227, v50
  v_dot2c_f32_bf16 v23, v227, v51
  v_dot2c_f32_bf16 v24, v228, v50
  v_dot2c_f32_bf16 v25, v228, v51
  v_dot2c_f32_bf16 v26, v229, v50
  v_dot2c_f32_bf16 v27, v229, v51
  v_dot2c_f32_bf16 v28, v230, v50
  v_dot2c_f32_bf16 v29, v230, v51
  v_dot2c_f32_bf16 v30, v231, v50
  v_dot2c_f32_bf16 v31, v231, v51
  v_dot2c_f32_bf16 v32, v232, v50
  v_dot2c_f32_bf16 v33, v232, v51
  v_dot2c_f32_bf16 v34, v233, v50
  v_dot2c_f32_bf16 v35, v233, v51
  v_dot2c_f32_bf16 v36, v234, v50
  v_dot2c_f32_bf16 v37, v234, v51
  v_dot2c_f32_bf16 v38, v235, v50
  v_dot2c_f32_bf16 v39, v235, v51
  v_dot2c_f32_bf16 v16, v236, v52
  v_dot2c_f32_bf16 v17, v236, v53
  v_dot2c_f32_bf16 v18, v237, v52
  v_dot2c_f32_bf16 v19, v237, v53
  v_dot2c_f32_bf16 v20, v238, v52
  v_dot2c_f32_bf16 v21, v238, v53
  v_dot2c_f32_bf16 v22, v239, v52
  v_dot2c_f32_bf16 v23, v239, v53
  v_dot2c_f32_bf16 v24, v240, v52
  v_dot2c_f32_bf16 v25, v240, v53
  v_dot2c_f32_bf16 v26, v241, v52
  v_dot2c_f32_bf16 v27, v241, v53
  v_dot2c_f32_bf16 v28, v242, v52
  v_dot2c_f32_bf16 v29, v242, v53
  v_dot2c_f32_bf16 v30, v243, v52
  v_dot2c_f32_bf16 v31, v243, v53
  v_dot2c_f32_bf16 v32, v244, v52
  v_dot2c_f32_bf16 v33, v244, v53
  v_dot2c_f32_bf16 v34, v245, v52
  v_dot2c_f32_bf16 v35, v245, v53
  v_dot2c_f32_bf16 v36, v246, v52
  v_dot2c_f32_bf16 v37, v246, v53
  v_dot2c_f32_bf16 v38, v247, v52
  v_dot2c_f32_bf16 v39, v247, v53
  s_mov_b32 s45, 28
.p2align 6
  s_nop 1
L_loop1:
  s_waitcnt vmcnt(0)
  buffer_load_dwordx4 v[80:83], v1, s[40:43], s44 offen offset:0 nt
  buffer_load_dwordx4 v[84:87], v1, s[40:43], s44 offen offset:128 nt
  buffer_load_dwordx4 v[88:91], v1, s[40:43], s44 offen offset:256 nt
  buffer_load_dwordx4 v[92:95], v1, s[40:43], s44 offen offset:3072 nt
  buffer_load_dwordx4 v[96:99], v1, s[40:43], s44 offen offset:3200 nt
  buffer_load_dwordx4 v[100:103], v1, s[40:43], s44 offen offset:3328 nt
  s_add_u32 s44, s44, 196608
  s_cmp_ge_u32 s44, s56
  s_cselect_b32 s46, 6291456, 0
  s_sub_u32 s44, s44, s46
  s_cmp_eq_u32 s45, 1
  s_cselect_b32 s46, 201326592, 0
  s_add_u32 s44, s44, s46
  v_mov_b32 v42, 0
  v_mov_b32 v43, 0
  v_dot2c_f32_bf16 v42, v56, v4
  v_dot2c_f32_bf16 v43, v68, v4
  v_dot2c_f32_bf16 v42, v57, v5
  v_dot2c_f32_bf16 v43, v69, v5
  v_dot2c_f32_bf16 v42, v58, v6
  v_dot2c_f32_bf16 v43, v70, v6
  v_dot2c_f32_bf16 v42, v59, v7
  v_dot2c_f32_bf16 v43, v71, v7
  v_dot2c_f32_bf16 v42, v60, v8
  v_dot2c_f32_bf16 v43, v72, v8
  v_dot2c_f32_bf16 v42, v61, v9
  v_dot2c_f32_bf16 v43, v73, v9
  v_dot2c_f32_bf16 v42, v62, v10
  v_dot2c_f32_bf16 v43, v74, v10
  v_dot2c_f32_bf16 v42, v63, v11
  v_dot2c_f32_bf16 v43, v75, v11
  v_dot2c_f32_bf16 v42, v64, v12
  v_dot2c_f32_bf16 v43, v76, v12
  v_dot2c_f32_bf16 v42, v65, v13
  v_dot2c_f32_bf16 v43, v77, v13
  v_dot2c_f32_bf16 v42, v66, v14
  v_dot2c_f32_bf16 v43, v78, v14
  v_dot2c_f32_bf16 v42, v67, v15
  v_dot2c_f32_bf16 v43, v79, v15
  s_nop 1
  v_add_f32_dpp v42, v42, v42 quad_perm:[1,0,3,2] row_mask:0xf bank_mask:0xf
  v_add_f32_dpp v43, v43, v43 quad_perm:[1,0,3,2] row_mask:0xf bank_mask:0xf
  s_nop 0
  v_add_f32_dpp v42, v42, v42 quad_perm:[2,3,0,1] row_mask:0xf bank_mask:0xf
  v_add_f32_dpp v43, v43, v43 quad_perm:[2,3,0,1] row_mask:0xf bank_mask:0xf
  s_nop 0
  v_add_f32_dpp v42, v42, v42 row_half_mirror row_mask:0xf bank_mask:0xf
  v_add_f32_dpp v43, v43, v43 row_half_mirror row_mask:0xf bank_mask:0xf
  v_cvt_pk_bf16_f32 v54, v42, v43
  v_lshlrev_b32 v42, 16, v54
  v_and_b32 v43, 0xffff0000, v54
  v_mul_f32 v42, s33, v42
  v_mul_f32 v43, s33, v43
  v_cvt_pk_bf16_f32 v54, v42, v43
  v_lshlrev_b32 v42, 16, v54
  v_and_b32 v43, 0xffff0000, v54
  v_mul_f32 v44, s34, v42
  v_mul_f32 v45, s34, v43
  v_max3_f32 v46, v40, v44, v45
  v_sub_f32 v48, v40, v46
  v_sub_f32 v44, v44, v46
  v_sub_f32 v45, v45, v46
  v_exp_f32 v48, v48
  v_exp_f32 v44, v44
  v_exp_f32 v45, v45
  v_mov_b32 v40, v46
  v_cvt_pk_bf16_f32 v54, v44, v45
  v_fma_f32 v41, v41, v48, v44
  v_and_b32 v50, 0xffff, v54
  v_lshlrev_b32 v51, 16, v54
  v_lshrrev_b32 v52, 16, v54
  v_and_b32 v53, 0xffff0000, v54
  v_add_f32 v41, v41, v45
  v_pk_mul_f32 v[16:17], v[16:17], v[48:49] op_sel_hi:[1,0]
  v_pk_mul_f32 v[18:19], v[18:19], v[48:49] op_sel_hi:[1,0]
  v_pk_mul_f32 v[20:21], v[20:21], v[48:49] op_sel_hi:[1,0]
  v_pk_mul_f32 v[22:23], v[22:23], v[48:49] op_sel_hi:[1,0]
  v_pk_mul_f32 v[24:25], v[24:25], v[48:49] op_sel_hi:[1,0]
  v_pk_mul_f32 v[26:27], v[26:27], v[48:49] op_sel_hi:[1,0]
  v_pk_mul_f32 v[28:29], v[28:29], v[48:49] op_sel_hi:[1,0]
  v_pk_mul_f32 v[30:31], v[30:31], v[48:49] op_sel_hi:[1,0]
  v_pk_mul_f32 v[32:33], v[32:33], v[48:49] op_sel_hi:[1,0]
  v_pk_mul_f32 v[34:35], v[34:35], v[48:49] op_sel_hi:[1,0]
  v_pk_mul_f32 v[36:37], v[36:37], v[48:49] op_sel_hi:[1,0]
  v_pk_mul_f32 v[38:39], v[38:39], v[48:49] op_sel_hi:[1,0]
  s_waitcnt vmcnt(0)
  buffer_load_dwordx4 v[56:59], v1, s[36:39], s44 offen offset:0 nt
  buffer_load_dwordx4 v[60:63], v1, s[36:39], s44 offen offset:128 nt
  buffer_load_dwordx4 v[64:67], v1, s[36:39], s44 offen offset:256 nt
  buffer_load_dwordx4 v[68:71], v1, s[36:39], s44 offen offset:3072 nt
  buffer_load_dwordx4 v[72:75], v1, s[36:39], s44 offen offset:3200 nt
  buffer_load_dwordx4 v[76:79], v1, s[36:39], s44 offen offset:3328 nt
  v_dot2c_f32_bf16 v16, v80, v50
  v_dot2c_f32_bf16 v17, v80, v51
  v_dot2c_f32_bf16 v18, v81, v50
  v_dot2c_f32_bf16 v19, v81, v51
  v_dot2c_f32_bf16 v20, v82, v50
  v_dot2c_f32_bf16 v21, v82, v51
  v_dot2c_f32_bf16 v22, v83, v50
  v_dot2c_f32_bf16 v23, v83, v51
  v_dot2c_f32_bf16 v24, v84, v50
  v_dot2c_f32_bf16 v25, v84, v51
  v_dot2c_f32_bf16 v26, v85, v50
  v_dot2c_f32_bf16 v27, v85, v51
  v_dot2c_f32_bf16 v28, v86, v50
  v_dot2c_f32_bf16 v29, v86, v51
  v_dot2c_f32_bf16 v30, v87, v50
  v_dot2c_f32_bf16 v31, v87, v51
  v_dot2c_f32_bf16 v32, v88, v50
  v_dot2c_f32_bf16 v33, v88, v51
  v_dot2c_f32_bf16 v34, v89, v50
  v_dot2c_f32_bf16 v35, v89, v51
  v_dot2c_f32_bf16 v36, v90, v50
  v_dot2c_f32_bf16 v37, v90, v51
  v_dot2c_f32_bf16 v38, v91, v50
  v_dot2c_f32_bf16 v39, v91, v51
  v_dot2c_f32_bf16 v16, v92, v52
  v_dot2c_f32_bf16 v17, v92, v53
  v_dot2c_f32_bf16 v18, v93, v52
  v_dot2c_f32_bf16 v19, v93, v53
  v_dot2c_f32_bf16 v20, v94, v52
  v_dot2c_f32_bf16 v21, v94, v53
  v_dot2c_f32_bf16 v22, v95, v52
  v_dot2c_f32_bf16 v23, v95, v53
  v_dot2c_f32_bf16 v24, v96, v52
  v_dot2c_f32_bf16 v25, v96, v53
  v_dot2c_f32_bf16 v26, v97, v52
  v_dot2c_f32_bf16 v27, v97, v53
  v_dot2c_f32_bf16 v28, v98, v52
  v_dot2c_f32_bf16 v29, v98, v53
  v_dot2c_f32_bf16 v30, v99, v52
  v_dot2c_f32_bf16 v31, v99, v53
  v_dot2c_f32_bf16 v32, v100, v52
  v_dot2c_f32_bf16 v33, v100, v53
  v_dot2c_f32_bf16 v34, v101, v52
  v_dot2c_f32_bf16 v35, v101, v53
  v_dot2c_f32_bf16 v36, v102, v52
  v_dot2c_f32_bf16 v37, v102, v53
  v_dot2c_f32_bf16 v38, v103, v52
  v_dot2c_f32_bf16 v39, v103, v53
  s_sub_u32 s45, s45, 1
  s_cmp_lg_u32 s45, 0
  s_cbranch_scc1 L_loop1
  s_mov_b32 s56, 207618048
  buffer_load_dwordx4 v[80:83], v1, s[40:43], s44 offen offset:0 nt
  buffer_load_dwordx4 v[84:87], v1, s[40:43], s44 offen offset:128 nt
  buffer_load_dwordx4 v[88:91], v1, s[40:43], s44 offen offset:256 nt
  buffer_load_dwordx4 v[92:95], v1, s[40:43], s44 offen offset:3072 nt
  buffer_load_dwordx4 v[96:99], v1, s[40:43], s44 offen offset:3200 nt
  buffer_load_dwordx4 v[100:103], v1, s[40:43], s44 offen offset:3328 nt
  v_max_f32_dpp v46, v40, v40 row_ror:8 row_mask:0xf bank_mask:0xf
  v_mov_b32 v54, v46
  s_nop 1
  v_permlane16_swap_b32 v46, v54
  v_max_f32 v46, v46, v54
  v_mov_b32 v54, v46
  s_nop 1
  v_permlane32_swap_b32 v46, v54
  v_max_f32 v46, v46, v54
  v_sub_f32 v48, v40, v46
  v_exp_f32 v48, v48
  v_and_b32 v2, 7, v0
  v_mul_u32_u24 v2, 96, v2
  v_lshrrev_b32 v3, 4, v0
  v_mul_u32_u24 v3, 24, v3
  v_pk_mul_f32 v[16:17], v[16:17], v[48:49] op_sel_hi:[1,0]
  v_pk_mul_f32 v[18:19], v[18:19], v[48:49] op_sel_hi:[1,0]
  v_pk_mul_f32 v[20:21], v[20:21], v[48:49] op_sel_hi:[1,0]
  v_pk_mul_f32 v[22:23], v[22:23], v[48:49] op_sel_hi:[1,0]
  v_pk_mul_f32 v[24:25], v[24:25], v[48:49] op_sel_hi:[1,0]
  v_pk_mul_f32 v[26:27], v[26:27], v[48:49] op_sel_hi:[1,0]
  v_pk_mul_f32 v[28:29], v[28:29], v[48:49] op_sel_hi:[1,0]
  v_pk_mul_f32 v[30:31], v[30:31], v[48:49] op_sel_hi:[1,0]
  v_pk_mul_f32 v[32:33], v[32:33], v[48:49] op_sel_hi:[1,0]
  v_pk_mul_f32 v[34:35], v[34:35], v[48:49] op_sel_hi:[1,0]
  v_pk_mul_f32 v[36:37], v[36:37], v[48:49] op_sel_hi:[1,0]
  v_pk_mul_f32 v[38:39], v[38:39], v[48:49] op_sel_hi:[1,0]
  v_mul_f32 v41, v41, v48
  v_add_u32 v2, v2, v3
  s_mul_i32 s46, s3, 784
  v_add_u32 v2, s46, v2
  v_permlane32_swap_b32 v16, v28
  v_permlane32_swap_b32 v17, v29
  v_permlane32_swap_b32 v18, v30
  v_permlane32_swap_b32 v19, v31
  v_permlane32_swap_b32 v20, v32
  v_permlane32_swap_b32 v21, v33
  v_permlane32_swap_b32 v22, v34
  v_permlane32_swap_b32 v23, v35
  v_permlane32_swap_b32 v24, v36
  v_permlane32_swap_b32 v25, v37
  v_permlane32_swap_b32 v26, v38
  v_permlane32_swap_b32 v27, v39
  v_add_f32 v16, v16, v28
  v_add_f32 v17, v17, v29
  v_add_f32 v18, v18, v30
  v_add_f32 v19, v19, v31
  v_add_f32 v20, v20, v32
  v_add_f32 v21, v21, v33
  v_add_f32 v22, v22, v34
  v_add_f32 v23, v23, v35
  v_add_f32 v24, v24, v36
  v_add_f32 v25, v25, v37
  v_add_f32 v26, v26, v38
  v_add_f32 v27, v27, v39
  v_permlane16_swap_b32 v16, v22
  v_permlane16_swap_b32 v17, v23
  v_permlane16_swap_b32 v18, v24
  v_permlane16_swap_b32 v19, v25
  v_permlane16_swap_b32 v20, v26
  v_permlane16_swap_b32 v21, v27
  v_add_f32 v16, v16, v22
  v_add_f32 v17, v17, v23
  v_add_f32 v18, v18, v24
  v_add_f32 v19, v19, v25
  v_add_f32 v20, v20, v26
  v_add_f32 v21, v21, v27
  v_add_f32_dpp v16, v16, v16 row_ror:8 row_mask:0xf bank_mask:0xf
  v_add_f32_dpp v17, v17, v17 row_ror:8 row_mask:0xf bank_mask:0xf
  v_add_f32_dpp v18, v18, v18 row_ror:8 row_mask:0xf bank_mask:0xf
  v_add_f32_dpp v19, v19, v19 row_ror:8 row_mask:0xf bank_mask:0xf
  v_add_f32_dpp v20, v20, v20 row_ror:8 row_mask:0xf bank_mask:0xf
  v_add_f32_dpp v21, v21, v21 row_ror:8 row_mask:0xf bank_mask:0xf
  v_add_f32_dpp v41, v41, v41 row_ror:8 row_mask:0xf bank_mask:0xf
  v_mov_b32 v54, v41
  s_nop 1
  v_permlane16_swap_b32 v41, v54
  v_add_f32 v41, v41, v54
  v_mov_b32 v54, v41
  s_nop 1
  v_permlane32_swap_b32 v41, v54
  v_add_f32 v41, v41, v54
  ds_write_b64 v2, v[16:17] offset:12096
  ds_write_b64 v2, v[18:19] offset:12104
  ds_write_b64 v2, v[20:21] offset:12112
  v_mov_b32 v44, v46
  v_mov_b32 v45, v41
  v_mov_b32 v2, s46
  ds_write_b64 v2, v[44:45] offset:12864
  s_waitcnt lgkmcnt(0)
  v_mov_b32 v2, 0
  v_mov_b32 v3, 1
  s_mov_b64 exec, 1
  ds_add_u32 v2, v3 offset:15872
  s_mov_b64 exec, -1
  s_mov_b32 s45, 262144
L_lw_q2:
  ds_read_b32 v3, v2 offset:15880
  s_waitcnt lgkmcnt(0)
  v_readfirstlane_b32 s46, v3
  s_nop 0
  s_cmp_ge_u32 s46, 1
  s_nop 1
  s_cbranch_scc1 L_lwok_q2
  s_sub_u32 s45, s45, 1
  s_cmp_eq_u32 s45, 0
  s_cbranch_scc1 L_lwok_q2
  s_sleep 8
  s_branch L_lw_q2
L_lwok_q2:
  v_and_b32 v2, 7, v0
  v_mul_u32_u24 v2, 48, v2
  ds_read_b128 v[4:7], v2 offset:8576
  ds_read_b128 v[8:11], v2 offset:8592
  ds_read_b128 v[12:15], v2 offset:8608
  v_mov_b32 v16, 0
  v_mov_b32 v17, 0
  v_mov_b32 v18, 0
  v_mov_b32 v19, 0
  v_mov_b32 v20, 0
  v_mov_b32 v21, 0
  v_mov_b32 v22, 0
  v_mov_b32 v23, 0
  v_mov_b32 v24, 0
  v_mov_b32 v25, 0
  v_mov_b32 v26, 0
  v_mov_b32 v27, 0
  v_mov_b32 v28, 0
  v_mov_b32 v29, 0
  v_mov_b32 v30, 0
  v_mov_b32 v31, 0
  v_mov_b32 v32, 0
  v_mov_b32 v33, 0
  v_mov_b32 v34, 0
  v_mov_b32 v35, 0
  v_mov_b32 v36, 0
  v_mov_b32 v37, 0
  v_mov_b32 v38, 0
  v_mov_b32 v39, 0
  v_mov_b32 v40, 0xf149f2ca
  v_mov_b32 v41, 0
  s_waitcnt lgkmcnt(0)
  s_mov_b32 s45, 0
  s_add_u32 s44, s44, 196608
  s_cmp_ge_u32 s44, s56
  s_cselect_b32 s46, 6291456, 0
  s_sub_u32 s44, s44, s46
  s_waitcnt vmcnt(6)
  v_mov_b32 v42, 0
  v_mov_b32 v43, 0
  v_dot2c_f32_bf16 v42, v56, v4
  v_dot2c_f32_bf16 v43, v68, v4
  v_dot2c_f32_bf16 v42, v57, v5
  v_dot2c_f32_bf16 v43, v69, v5
  v_dot2c_f32_bf16 v42, v58, v6
  v_dot2c_f32_bf16 v43, v70, v6
  v_dot2c_f32_bf16 v42, v59, v7
  v_dot2c_f32_bf16 v43, v71, v7
  v_dot2c_f32_bf16 v42, v60, v8
  v_dot2c_f32_bf16 v43, v72, v8
  v_dot2c_f32_bf16 v42, v61, v9
  v_dot2c_f32_bf16 v43, v73, v9
  v_dot2c_f32_bf16 v42, v62, v10
  v_dot2c_f32_bf16 v43, v74, v10
  v_dot2c_f32_bf16 v42, v63, v11
  v_dot2c_f32_bf16 v43, v75, v11
  v_dot2c_f32_bf16 v42, v64, v12
  v_dot2c_f32_bf16 v43, v76, v12
  v_dot2c_f32_bf16 v42, v65, v13
  v_dot2c_f32_bf16 v43, v77, v13
  v_dot2c_f32_bf16 v42, v66, v14
  v_dot2c_f32_bf16 v43, v78, v14
  v_dot2c_f32_bf16 v42, v67, v15
  v_dot2c_f32_bf16 v43, v79, v15
  s_nop 1
  v_add_f32_dpp v42, v42, v42 quad_perm:[1,0,3,2] row_mask:0xf bank_mask:0xf
  v_add_f32_dpp v43, v43, v43 quad_perm:[1,0,3,2] row_mask:0xf bank_mask:0xf
  s_nop 0
  v_add_f32_dpp v42, v42, v42 quad_perm:[2,3,0,1] row_mask:0xf bank_mask:0xf
  v_add_f32_dpp v43, v43, v43 quad_perm:[2,3,0,1] row_mask:0xf bank_mask:0xf
  s_nop 0
  v_add_f32_dpp v42, v42, v42 row_half_mirror row_mask:0xf bank_mask:0xf
  v_add_f32_dpp v43, v43, v43 row_half_mirror row_mask:0xf bank_mask:0xf
  v_cvt_pk_bf16_f32 v54, v42, v43
  v_lshlrev_b32 v42, 16, v54
  v_and_b32 v43, 0xffff0000, v54
  v_mul_f32 v42, s33, v42
  v_mul_f32 v43, s33, v43
  v_cvt_pk_bf16_f32 v54, v42, v43
  v_lshlrev_b32 v42, 16, v54
  v_and_b32 v43, 0xffff0000, v54
  v_mul_f32 v44, s34, v42
  v_mul_f32 v45, s34, v43
  v_max3_f32 v46, v40, v44, v45
  v_sub_f32 v48, v40, v46
  v_sub_f32 v44, v44, v46
  v_sub_f32 v45, v45, v46
  v_exp_f32 v48, v48
  v_exp_f32 v44, v44
  v_exp_f32 v45, v45
  v_mov_b32 v40, v46
  v_cvt_pk_bf16_f32 v54, v44, v45
  v_fma_f32 v41, v41, v48, v44
  v_and_b32 v50, 0xffff, v54
  v_lshlrev_b32 v51, 16, v54
  v_lshrrev_b32 v52, 16, v54
  v_and_b32 v53, 0xffff0000, v54
  v_add_f32 v41, v41, v45
  v_pk_mul_f32 v[16:17], v[16:17], v[48:49] op_sel_hi:[1,0]
  v_pk_mul_f32 v[18:19], v[18:19], v[48:49] op_sel_hi:[1,0]
  v_pk_mul_f32 v[20:21], v[20:21], v[48:49] op_sel_hi:[1,0]
  v_pk_mul_f32 v[22:23], v[22:23], v[48:49] op_sel_hi:[1,0]
  v_pk_mul_f32 v[24:25], v[24:25], v[48:49] op_sel_hi:[1,0]
  v_pk_mul_f32 v[26:27], v[26:27], v[48:49] op_sel_hi:[1,0]
  v_pk_mul_f32 v[28:29], v[28:29], v[48:49] op_sel_hi:[1,0]
  v_pk_mul_f32 v[30:31], v[30:31], v[48:49] op_sel_hi:[1,0]
  v_pk_mul_f32 v[32:33], v[32:33], v[48:49] op_sel_hi:[1,0]
  v_pk_mul_f32 v[34:35], v[34:35], v[48:49] op_sel_hi:[1,0]
  v_pk_mul_f32 v[36:37], v[36:37], v[48:49] op_sel_hi:[1,0]
  v_pk_mul_f32 v[38:39], v[38:39], v[48:49] op_sel_hi:[1,0]
  s_waitcnt vmcnt(0)
  buffer_load_dwordx4 v[56:59], v1, s[36:39], s44 offen offset:0 nt
  buffer_load_dwordx4 v[60:63], v1, s[36:39], s44 offen offset:128 nt
  buffer_load_dwordx4 v[64:67], v1, s[36:39], s44 offen offset:256 nt
  buffer_load_dwordx4 v[68:71], v1, s[36:39], s44 offen offset:3072 nt
  buffer_load_dwordx4 v[72:75], v1, s[36:39], s44 offen offset:3200 nt
  buffer_load_dwordx4 v[76:79], v1, s[36:39], s44 offen offset:3328 nt
  v_dot2c_f32_bf16 v16, v80, v50
  v_dot2c_f32_bf16 v17, v80, v51
  v_dot2c_f32_bf16 v18, v81, v50
  v_dot2c_f32_bf16 v19, v81, v51
  v_dot2c_f32_bf16 v20, v82, v50
  v_dot2c_f32_bf16 v21, v82, v51
  v_dot2c_f32_bf16 v22, v83, v50
  v_dot2c_f32_bf16 v23, v83, v51
  v_dot2c_f32_bf16 v24, v84, v50
  v_dot2c_f32_bf16 v25, v84, v51
  v_dot2c_f32_bf16 v26, v85, v50
  v_dot2c_f32_bf16 v27, v85, v51
  v_dot2c_f32_bf16 v28, v86, v50
  v_dot2c_f32_bf16 v29, v86, v51
  v_dot2c_f32_bf16 v30, v87, v50
  v_dot2c_f32_bf16 v31, v87, v51
  v_dot2c_f32_bf16 v32, v88, v50
  v_dot2c_f32_bf16 v33, v88, v51
  v_dot2c_f32_bf16 v34, v89, v50
  v_dot2c_f32_bf16 v35, v89, v51
  v_dot2c_f32_bf16 v36, v90, v50
  v_dot2c_f32_bf16 v37, v90, v51
  v_dot2c_f32_bf16 v38, v91, v50
  v_dot2c_f32_bf16 v39, v91, v51
  v_dot2c_f32_bf16 v16, v92, v52
  v_dot2c_f32_bf16 v17, v92, v53
  v_dot2c_f32_bf16 v18, v93, v52
  v_dot2c_f32_bf16 v19, v93, v53
  v_dot2c_f32_bf16 v20, v94, v52
  v_dot2c_f32_bf16 v21, v94, v53
  v_dot2c_f32_bf16 v22, v95, v52
  v_dot2c_f32_bf16 v23, v95, v53
  v_dot2c_f32_bf16 v24, v96, v52
  v_dot2c_f32_bf16 v25, v96, v53
  v_dot2c_f32_bf16 v26, v97, v52
  v_dot2c_f32_bf16 v27, v97, v53
  v_dot2c_f32_bf16 v28, v98, v52
  v_dot2c_f32_bf16 v29, v98, v53
  v_dot2c_f32_bf16 v30, v99, v52
  v_dot2c_f32_bf16 v31, v99, v53
  v_dot2c_f32_bf16 v32, v100, v52
  v_dot2c_f32_bf16 v33, v100, v53
  v_dot2c_f32_bf16 v34, v101, v52
  v_dot2c_f32_bf16 v35, v101, v53
  v_dot2c_f32_bf16 v36, v102, v52
  v_dot2c_f32_bf16 v37, v102, v53
  v_dot2c_f32_bf16 v38, v103, v52
  v_dot2c_f32_bf16 v39, v103, v53
  s_mov_b32 s45, 24
.p2align 6
  s_nop 1
L_loop2:
  s_waitcnt vmcnt(0)
  buffer_load_dwordx4 v[80:83], v1, s[40:43], s44 offen offset:0 nt
  buffer_load_dwordx4 v[84:87], v1, s[40:43], s44 offen offset:128 nt
  buffer_load_dwordx4 v[88:91], v1, s[40:43], s44 offen offset:256 nt
  buffer_load_dwordx4 v[92:95], v1, s[40:43], s44 offen offset:3072 nt
  buffer_load_dwordx4 v[96:99], v1, s[40:43], s44 offen offset:3200 nt
  buffer_load_dwordx4 v[100:103], v1, s[40:43], s44 offen offset:3328 nt
  s_add_u32 s44, s44, 196608
  s_cmp_ge_u32 s44, s56
  s_cselect_b32 s46, 6291456, 0
  s_sub_u32 s44, s44, s46
  v_mov_b32 v42, 0
  v_mov_b32 v43, 0
  v_dot2c_f32_bf16 v42, v56, v4
  v_dot2c_f32_bf16 v43, v68, v4
  v_dot2c_f32_bf16 v42, v57, v5
  v_dot2c_f32_bf16 v43, v69, v5
  v_dot2c_f32_bf16 v42, v58, v6
  v_dot2c_f32_bf16 v43, v70, v6
  v_dot2c_f32_bf16 v42, v59, v7
  v_dot2c_f32_bf16 v43, v71, v7
  v_dot2c_f32_bf16 v42, v60, v8
  v_dot2c_f32_bf16 v43, v72, v8
  v_dot2c_f32_bf16 v42, v61, v9
  v_dot2c_f32_bf16 v43, v73, v9
  v_dot2c_f32_bf16 v42, v62, v10
  v_dot2c_f32_bf16 v43, v74, v10
  v_dot2c_f32_bf16 v42, v63, v11
  v_dot2c_f32_bf16 v43, v75, v11
  v_dot2c_f32_bf16 v42, v64, v12
  v_dot2c_f32_bf16 v43, v76, v12
  v_dot2c_f32_bf16 v42, v65, v13
  v_dot2c_f32_bf16 v43, v77, v13
  v_dot2c_f32_bf16 v42, v66, v14
  v_dot2c_f32_bf16 v43, v78, v14
  v_dot2c_f32_bf16 v42, v67, v15
  v_dot2c_f32_bf16 v43, v79, v15
  s_nop 1
  v_add_f32_dpp v42, v42, v42 quad_perm:[1,0,3,2] row_mask:0xf bank_mask:0xf
  v_add_f32_dpp v43, v43, v43 quad_perm:[1,0,3,2] row_mask:0xf bank_mask:0xf
  s_nop 0
  v_add_f32_dpp v42, v42, v42 quad_perm:[2,3,0,1] row_mask:0xf bank_mask:0xf
  v_add_f32_dpp v43, v43, v43 quad_perm:[2,3,0,1] row_mask:0xf bank_mask:0xf
  s_nop 0
  v_add_f32_dpp v42, v42, v42 row_half_mirror row_mask:0xf bank_mask:0xf
  v_add_f32_dpp v43, v43, v43 row_half_mirror row_mask:0xf bank_mask:0xf
  v_cvt_pk_bf16_f32 v54, v42, v43
  v_lshlrev_b32 v42, 16, v54
  v_and_b32 v43, 0xffff0000, v54
  v_mul_f32 v42, s33, v42
  v_mul_f32 v43, s33, v43
  v_cvt_pk_bf16_f32 v54, v42, v43
  v_lshlrev_b32 v42, 16, v54
  v_and_b32 v43, 0xffff0000, v54
  v_mul_f32 v44, s34, v42
  v_mul_f32 v45, s34, v43
  v_max3_f32 v46, v40, v44, v45
  v_sub_f32 v48, v40, v46
  v_sub_f32 v44, v44, v46
  v_sub_f32 v45, v45, v46
  v_exp_f32 v48, v48
  v_exp_f32 v44, v44
  v_exp_f32 v45, v45
  v_mov_b32 v40, v46
  v_cvt_pk_bf16_f32 v54, v44, v45
  v_fma_f32 v41, v41, v48, v44
  v_and_b32 v50, 0xffff, v54
  v_lshlrev_b32 v51, 16, v54
  v_lshrrev_b32 v52, 16, v54
  v_and_b32 v53, 0xffff0000, v54
  v_add_f32 v41, v41, v45
  v_pk_mul_f32 v[16:17], v[16:17], v[48:49] op_sel_hi:[1,0]
  v_pk_mul_f32 v[18:19], v[18:19], v[48:49] op_sel_hi:[1,0]
  v_pk_mul_f32 v[20:21], v[20:21], v[48:49] op_sel_hi:[1,0]
  v_pk_mul_f32 v[22:23], v[22:23], v[48:49] op_sel_hi:[1,0]
  v_pk_mul_f32 v[24:25], v[24:25], v[48:49] op_sel_hi:[1,0]
  v_pk_mul_f32 v[26:27], v[26:27], v[48:49] op_sel_hi:[1,0]
  v_pk_mul_f32 v[28:29], v[28:29], v[48:49] op_sel_hi:[1,0]
  v_pk_mul_f32 v[30:31], v[30:31], v[48:49] op_sel_hi:[1,0]
  v_pk_mul_f32 v[32:33], v[32:33], v[48:49] op_sel_hi:[1,0]
  v_pk_mul_f32 v[34:35], v[34:35], v[48:49] op_sel_hi:[1,0]
  v_pk_mul_f32 v[36:37], v[36:37], v[48:49] op_sel_hi:[1,0]
  v_pk_mul_f32 v[38:39], v[38:39], v[48:49] op_sel_hi:[1,0]
  s_waitcnt vmcnt(0)
  buffer_load_dwordx4 v[56:59], v1, s[36:39], s44 offen offset:0 nt
  buffer_load_dwordx4 v[60:63], v1, s[36:39], s44 offen offset:128 nt
  buffer_load_dwordx4 v[64:67], v1, s[36:39], s44 offen offset:256 nt
  buffer_load_dwordx4 v[68:71], v1, s[36:39], s44 offen offset:3072 nt
  buffer_load_dwordx4 v[72:75], v1, s[36:39], s44 offen offset:3200 nt
  buffer_load_dwordx4 v[76:79], v1, s[36:39], s44 offen offset:3328 nt
  v_dot2c_f32_bf16 v16, v80, v50
  v_dot2c_f32_bf16 v17, v80, v51
  v_dot2c_f32_bf16 v18, v81, v50
  v_dot2c_f32_bf16 v19, v81, v51
  v_dot2c_f32_bf16 v20, v82, v50
  v_dot2c_f32_bf16 v21, v82, v51
  v_dot2c_f32_bf16 v22, v83, v50
  v_dot2c_f32_bf16 v23, v83, v51
  v_dot2c_f32_bf16 v24, v84, v50
  v_dot2c_f32_bf16 v25, v84, v51
  v_dot2c_f32_bf16 v26, v85, v50
  v_dot2c_f32_bf16 v27, v85, v51
  v_dot2c_f32_bf16 v28, v86, v50
  v_dot2c_f32_bf16 v29, v86, v51
  v_dot2c_f32_bf16 v30, v87, v50
  v_dot2c_f32_bf16 v31, v87, v51
  v_dot2c_f32_bf16 v32, v88, v50
  v_dot2c_f32_bf16 v33, v88, v51
  v_dot2c_f32_bf16 v34, v89, v50
  v_dot2c_f32_bf16 v35, v89, v51
  v_dot2c_f32_bf16 v36, v90, v50
  v_dot2c_f32_bf16 v37, v90, v51
  v_dot2c_f32_bf16 v38, v91, v50
  v_dot2c_f32_bf16 v39, v91, v51
  v_dot2c_f32_bf16 v16, v92, v52
  v_dot2c_f32_bf16 v17, v92, v53
  v_dot2c_f32_bf16 v18, v93, v52
  v_dot2c_f32_bf16 v19, v93, v53
  v_dot2c_f32_bf16 v20, v94, v52
  v_dot2c_f32_bf16 v21, v94, v53
  v_dot2c_f32_bf16 v22, v95, v52
  v_dot2c_f32_bf16 v23, v95, v53
  v_dot2c_f32_bf16 v24, v96, v52
  v_dot2c_f32_bf16 v25, v96, v53
  v_dot2c_f32_bf16 v26, v97, v52
  v_dot2c_f32_bf16 v27, v97, v53
  v_dot2c_f32_bf16 v28, v98, v52
  v_dot2c_f32_bf16 v29, v98, v53
  v_dot2c_f32_bf16 v30, v99, v52
  v_dot2c_f32_bf16 v31, v99, v53
  v_dot2c_f32_bf16 v32, v100, v52
  v_dot2c_f32_bf16 v33, v100, v53
  v_dot2c_f32_bf16 v34, v101, v52
  v_dot2c_f32_bf16 v35, v101, v53
  v_dot2c_f32_bf16 v36, v102, v52
  v_dot2c_f32_bf16 v37, v102, v53
  v_dot2c_f32_bf16 v38, v103, v52
  v_dot2c_f32_bf16 v39, v103, v53
  s_sub_u32 s45, s45, 1
  s_cmp_lg_u32 s45, 0
  s_cbranch_scc1 L_loop2
  v_mov_b32 v2, 0
  s_mov_b64 exec, 1
  v_mov_b32 v3, 1
  ds_max_u32 v2, v3 offset:16448
  s_mov_b64 exec, -1
  s_mov_b32 s45, 1
.p2align 6
L_loop2b:
  s_waitcnt vmcnt(0)
  buffer_load_dwordx4 v[80:83], v1, s[40:43], s44 offen offset:0 nt
  buffer_load_dwordx4 v[84:87], v1, s[40:43], s44 offen offset:128 nt
  buffer_load_dwordx4 v[88:91], v1, s[40:43], s44 offen offset:256 nt
  buffer_load_dwordx4 v[92:95], v1, s[40:43], s44 offen offset:3072 nt
  buffer_load_dwordx4 v[96:99], v1, s[40:43], s44 offen offset:3200 nt
  buffer_load_dwordx4 v[100:103], v1, s[40:43], s44 offen offset:3328 nt
  s_add_u32 s44, s44, 196608
  s_cmp_ge_u32 s44, s56
  s_cselect_b32 s46, 6291456, 0
  s_sub_u32 s44, s44, s46
  v_mov_b32 v42, 0
  v_mov_b32 v43, 0
  v_dot2c_f32_bf16 v42, v56, v4
  v_dot2c_f32_bf16 v43, v68, v4
  v_dot2c_f32_bf16 v42, v57, v5
  v_dot2c_f32_bf16 v43, v69, v5
  v_dot2c_f32_bf16 v42, v58, v6
  v_dot2c_f32_bf16 v43, v70, v6
  v_dot2c_f32_bf16 v42, v59, v7
  v_dot2c_f32_bf16 v43, v71, v7
  v_dot2c_f32_bf16 v42, v60, v8
  v_dot2c_f32_bf16 v43, v72, v8
  v_dot2c_f32_bf16 v42, v61, v9
  v_dot2c_f32_bf16 v43, v73, v9
  v_dot2c_f32_bf16 v42, v62, v10
  v_dot2c_f32_bf16 v43, v74, v10
  v_dot2c_f32_bf16 v42, v63, v11
  v_dot2c_f32_bf16 v43, v75, v11
  v_dot2c_f32_bf16 v42, v64, v12
  v_dot2c_f32_bf16 v43, v76, v12
  v_dot2c_f32_bf16 v42, v65, v13
  v_dot2c_f32_bf16 v43, v77, v13
  v_dot2c_f32_bf16 v42, v66, v14
  v_dot2c_f32_bf16 v43, v78, v14
  v_dot2c_f32_bf16 v42, v67, v15
  v_dot2c_f32_bf16 v43, v79, v15
  s_nop 1
  v_add_f32_dpp v42, v42, v42 quad_perm:[1,0,3,2] row_mask:0xf bank_mask:0xf
  v_add_f32_dpp v43, v43, v43 quad_perm:[1,0,3,2] row_mask:0xf bank_mask:0xf
  s_nop 0
  v_add_f32_dpp v42, v42, v42 quad_perm:[2,3,0,1] row_mask:0xf bank_mask:0xf
  v_add_f32_dpp v43, v43, v43 quad_perm:[2,3,0,1] row_mask:0xf bank_mask:0xf
  s_nop 0
  v_add_f32_dpp v42, v42, v42 row_half_mirror row_mask:0xf bank_mask:0xf
  v_add_f32_dpp v43, v43, v43 row_half_mirror row_mask:0xf bank_mask:0xf
  v_cvt_pk_bf16_f32 v54, v42, v43
  v_lshlrev_b32 v42, 16, v54
  v_and_b32 v43, 0xffff0000, v54
  v_mul_f32 v42, s33, v42
  v_mul_f32 v43, s33, v43
  v_cvt_pk_bf16_f32 v54, v42, v43
  v_lshlrev_b32 v42, 16, v54
  v_and_b32 v43, 0xffff0000, v54
  v_mul_f32 v44, s34, v42
  v_mul_f32 v45, s34, v43
  v_max3_f32 v46, v40, v44, v45
  v_sub_f32 v48, v40, v46
  v_sub_f32 v44, v44, v46
  v_sub_f32 v45, v45, v46
  v_exp_f32 v48, v48
  v_exp_f32 v44, v44
  v_exp_f32 v45, v45
  v_mov_b32 v40, v46
  v_cvt_pk_bf16_f32 v54, v44, v45
  v_fma_f32 v41, v41, v48, v44
  v_and_b32 v50, 0xffff, v54
  v_lshlrev_b32 v51, 16, v54
  v_lshrrev_b32 v52, 16, v54
  v_and_b32 v53, 0xffff0000, v54
  v_add_f32 v41, v41, v45
  v_pk_mul_f32 v[16:17], v[16:17], v[48:49] op_sel_hi:[1,0]
  v_pk_mul_f32 v[18:19], v[18:19], v[48:49] op_sel_hi:[1,0]
  v_pk_mul_f32 v[20:21], v[20:21], v[48:49] op_sel_hi:[1,0]
  v_pk_mul_f32 v[22:23], v[22:23], v[48:49] op_sel_hi:[1,0]
  v_pk_mul_f32 v[24:25], v[24:25], v[48:49] op_sel_hi:[1,0]
  v_pk_mul_f32 v[26:27], v[26:27], v[48:49] op_sel_hi:[1,0]
  v_pk_mul_f32 v[28:29], v[28:29], v[48:49] op_sel_hi:[1,0]
  v_pk_mul_f32 v[30:31], v[30:31], v[48:49] op_sel_hi:[1,0]
  v_pk_mul_f32 v[32:33], v[32:33], v[48:49] op_sel_hi:[1,0]
  v_pk_mul_f32 v[34:35], v[34:35], v[48:49] op_sel_hi:[1,0]
  v_pk_mul_f32 v[36:37], v[36:37], v[48:49] op_sel_hi:[1,0]
  v_pk_mul_f32 v[38:39], v[38:39], v[48:49] op_sel_hi:[1,0]
  s_waitcnt vmcnt(0)
  buffer_load_dwordx4 v[56:59], v1, s[36:39], s44 offen offset:0 nt
  buffer_load_dwordx4 v[60:63], v1, s[36:39], s44 offen offset:128 nt
  buffer_load_dwordx4 v[64:67], v1, s[36:39], s44 offen offset:256 nt
  buffer_load_dwordx4 v[68:71], v1, s[36:39], s44 offen offset:3072 nt
  buffer_load_dwordx4 v[72:75], v1, s[36:39], s44 offen offset:3200 nt
  buffer_load_dwordx4 v[76:79], v1, s[36:39], s44 offen offset:3328 nt
  v_dot2c_f32_bf16 v16, v80, v50
  v_dot2c_f32_bf16 v17, v80, v51
  v_dot2c_f32_bf16 v18, v81, v50
  v_dot2c_f32_bf16 v19, v81, v51
  v_dot2c_f32_bf16 v20, v82, v50
  v_dot2c_f32_bf16 v21, v82, v51
  v_dot2c_f32_bf16 v22, v83, v50
  v_dot2c_f32_bf16 v23, v83, v51
  v_dot2c_f32_bf16 v24, v84, v50
  v_dot2c_f32_bf16 v25, v84, v51
  v_dot2c_f32_bf16 v26, v85, v50
  v_dot2c_f32_bf16 v27, v85, v51
  v_dot2c_f32_bf16 v28, v86, v50
  v_dot2c_f32_bf16 v29, v86, v51
  v_dot2c_f32_bf16 v30, v87, v50
  v_dot2c_f32_bf16 v31, v87, v51
  v_dot2c_f32_bf16 v32, v88, v50
  v_dot2c_f32_bf16 v33, v88, v51
  v_dot2c_f32_bf16 v34, v89, v50
  v_dot2c_f32_bf16 v35, v89, v51
  v_dot2c_f32_bf16 v36, v90, v50
  v_dot2c_f32_bf16 v37, v90, v51
  v_dot2c_f32_bf16 v38, v91, v50
  v_dot2c_f32_bf16 v39, v91, v51
  v_dot2c_f32_bf16 v16, v92, v52
  v_dot2c_f32_bf16 v17, v92, v53
  v_dot2c_f32_bf16 v18, v93, v52
  v_dot2c_f32_bf16 v19, v93, v53
  v_dot2c_f32_bf16 v20, v94, v52
  v_dot2c_f32_bf16 v21, v94, v53
  v_dot2c_f32_bf16 v22, v95, v52
  v_dot2c_f32_bf16 v23, v95, v53
  v_dot2c_f32_bf16 v24, v96, v52
  v_dot2c_f32_bf16 v25, v96, v53
  v_dot2c_f32_bf16 v26, v97, v52
  v_dot2c_f32_bf16 v27, v97, v53
  v_dot2c_f32_bf16 v28, v98, v52
  v_dot2c_f32_bf16 v29, v98, v53
  v_dot2c_f32_bf16 v30, v99, v52
  v_dot2c_f32_bf16 v31, v99, v53
  v_dot2c_f32_bf16 v32, v100, v52
  v_dot2c_f32_bf16 v33, v100, v53
  v_dot2c_f32_bf16 v34, v101, v52
  v_dot2c_f32_bf16 v35, v101, v53
  v_dot2c_f32_bf16 v36, v102, v52
  v_dot2c_f32_bf16 v37, v102, v53
  v_dot2c_f32_bf16 v38, v103, v52
  v_dot2c_f32_bf16 v39, v103, v53
  s_sub_u32 s45, s45, 1
  s_cmp_lg_u32 s45, 0
  s_cbranch_scc1 L_loop2b
  s_mov_b32 s47, 0
  v_mov_b32 v55, 16512
.p2align 6
  s_nop 1
L_loopd:
  s_waitcnt vmcnt(0)
  buffer_load_dwordx4 v[80:83], v1, s[40:43], s44 offen offset:0 nt
  buffer_load_dwordx4 v[84:87], v1, s[40:43], s44 offen offset:128 nt
  buffer_load_dwordx4 v[88:91], v1, s[40:43], s44 offen offset:256 nt
  buffer_load_dwordx4 v[92:95], v1, s[40:43], s44 offen offset:3072 nt
  buffer_load_dwordx4 v[96:99], v1, s[40:43], s44 offen offset:3200 nt
  buffer_load_dwordx4 v[100:103], v1, s[40:43], s44 offen offset:3328 nt
  ds_read_b32 v3, v55
  v_mov_b32 v42, 0
  v_mov_b32 v43, 0
  v_dot2c_f32_bf16 v42, v56, v4
  v_dot2c_f32_bf16 v43, v68, v4
  v_dot2c_f32_bf16 v42, v57, v5
  v_dot2c_f32_bf16 v43, v69, v5
  v_dot2c_f32_bf16 v42, v58, v6
  v_dot2c_f32_bf16 v43, v70, v6
  v_dot2c_f32_bf16 v42, v59, v7
  v_dot2c_f32_bf16 v43, v71, v7
  v_dot2c_f32_bf16 v42, v60, v8
  v_dot2c_f32_bf16 v43, v72, v8
  v_dot2c_f32_bf16 v42, v61, v9
  v_dot2c_f32_bf16 v43, v73, v9
  v_dot2c_f32_bf16 v42, v62, v10
  v_dot2c_f32_bf16 v43, v74, v10
  v_dot2c_f32_bf16 v42, v63, v11
  v_dot2c_f32_bf16 v43, v75, v11
  v_dot2c_f32_bf16 v42, v64, v12
  v_dot2c_f32_bf16 v43, v76, v12
  v_dot2c_f32_bf16 v42, v65, v13
  v_dot2c_f32_bf16 v43, v77, v13
  v_dot2c_f32_bf16 v42, v66, v14
  v_dot2c_f32_bf16 v43, v78, v14
  v_dot2c_f32_bf16 v42, v67, v15
  v_dot2c_f32_bf16 v43, v79, v15
  s_nop 1
  v_add_f32_dpp v42, v42, v42 quad_perm:[1,0,3,2] row_mask:0xf bank_mask:0xf
  v_add_f32_dpp v43, v43, v43 quad_perm:[1,0,3,2] row_mask:0xf bank_mask:0xf
  s_nop 0
  v_add_f32_dpp v42, v42, v42 quad_perm:[2,3,0,1] row_mask:0xf bank_mask:0xf
  v_add_f32_dpp v43, v43, v43 quad_perm:[2,3,0,1] row_mask:0xf bank_mask:0xf
  s_nop 0
  v_add_f32_dpp v42, v42, v42 row_half_mirror row_mask:0xf bank_mask:0xf
  v_add_f32_dpp v43, v43, v43 row_half_mirror row_mask:0xf bank_mask:0xf
  v_cvt_pk_bf16_f32 v54, v42, v43
  v_lshlrev_b32 v42, 16, v54
  v_and_b32 v43, 0xffff0000, v54
  v_mul_f32 v42, s33, v42
  v_mul_f32 v43, s33, v43
  v_cvt_pk_bf16_f32 v54, v42, v43
  v_lshlrev_b32 v42, 16, v54
  v_and_b32 v43, 0xffff0000, v54
  v_mul_f32 v44, s34, v42
  v_mul_f32 v45, s34, v43
  v_max3_f32 v46, v40, v44, v45
  v_sub_f32 v48, v40, v46
  v_sub_f32 v44, v44, v46
  v_sub_f32 v45, v45, v46
  v_exp_f32 v48, v48
  v_exp_f32 v44, v44
  v_exp_f32 v45, v45
  v_mov_b32 v40, v46
  v_cvt_pk_bf16_f32 v54, v44, v45
  v_fma_f32 v41, v41, v48, v44
  v_and_b32 v50, 0xffff, v54
  v_lshlrev_b32 v51, 16, v54
  v_lshrrev_b32 v52, 16, v54
  v_and_b32 v53, 0xffff0000, v54
  v_add_f32 v41, v41, v45
  v_pk_mul_f32 v[16:17], v[16:17], v[48:49] op_sel_hi:[1,0]
  v_pk_mul_f32 v[18:19], v[18:19], v[48:49] op_sel_hi:[1,0]
  v_pk_mul_f32 v[20:21], v[20:21], v[48:49] op_sel_hi:[1,0]
  v_pk_mul_f32 v[22:23], v[22:23], v[48:49] op_sel_hi:[1,0]
  v_pk_mul_f32 v[24:25], v[24:25], v[48:49] op_sel_hi:[1,0]
  v_pk_mul_f32 v[26:27], v[26:27], v[48:49] op_sel_hi:[1,0]
  v_pk_mul_f32 v[28:29], v[28:29], v[48:49] op_sel_hi:[1,0]
  v_pk_mul_f32 v[30:31], v[30:31], v[48:49] op_sel_hi:[1,0]
  v_pk_mul_f32 v[32:33], v[32:33], v[48:49] op_sel_hi:[1,0]
  v_pk_mul_f32 v[34:35], v[34:35], v[48:49] op_sel_hi:[1,0]
  v_pk_mul_f32 v[36:37], v[36:37], v[48:49] op_sel_hi:[1,0]
  v_pk_mul_f32 v[38:39], v[38:39], v[48:49] op_sel_hi:[1,0]
  s_mov_b32 s45, 2097152
  s_nop 0
L_tk_wait:
  s_waitcnt vmcnt(0) lgkmcnt(0)
  v_readfirstlane_b32 s46, v3
  s_nop 0
  s_cmp_lg_u32 s46, -1
  s_nop 1
  s_cbranch_scc1 L_tk_got
  s_sub_u32 s45, s45, 1
  s_cmp_eq_u32 s45, 0
  s_cbranch_scc1 L_last_tile
  ds_read_b32 v3, v55
  s_branch L_tk_wait
L_tk_got:
  s_cmp_ge_u32 s46, 2048
  s_cbranch_scc1 L_last_tile
  s_cmp_ge_u32 s46, 1984
  s_cbranch_scc1 L_e_mid
  s_add_u32 s46, s46, s3
  s_add_u32 s46, s46, s57
  s_and_b32 s46, s46, 1023
  s_mul_i32 s44, s46, 6144
  s_add_u32 s44, s44, 201326592
  buffer_load_dwordx4 v[56:59], v1, s[36:39], s44 offen offset:0 nt
  buffer_load_dwordx4 v[60:63], v1, s[36:39], s44 offen offset:128 nt
  buffer_load_dwordx4 v[64:67], v1, s[36:39], s44 offen offset:256 nt
  buffer_load_dwordx4 v[68:71], v1, s[36:39], s44 offen offset:3072 nt
  buffer_load_dwordx4 v[72:75], v1, s[36:39], s44 offen offset:3200 nt
  buffer_load_dwordx4 v[76:79], v1, s[36:39], s44 offen offset:3328 nt
  s_add_u32 s47, s47, 1
  s_add_u32 s46, s47, 1
  v_add_u32 v55, 4, v55
  s_mov_b64 exec, 1
  v_mov_b32 v3, s46
  ds_max_u32 v2, v3 offset:16448
  s_mov_b64 exec, -1
  v_dot2c_f32_bf16 v16, v80, v50
  v_dot2c_f32_bf16 v17, v80, v51
  v_dot2c_f32_bf16 v18, v81, v50
  v_dot2c_f32_bf16 v19, v81, v51
  v_dot2c_f32_bf16 v20, v82, v50
  v_dot2c_f32_bf16 v21, v82, v51
  v_dot2c_f32_bf16 v22, v83, v50
  v_dot2c_f32_bf16 v23, v83, v51
  v_dot2c_f32_bf16 v24, v84, v50
  v_dot2c_f32_bf16 v25, v84, v51
  v_dot2c_f32_bf16 v26, v85, v50
  v_dot2c_f32_bf16 v27, v85, v51
  v_dot2c_f32_bf16 v28, v86, v50
  v_dot2c_f32_bf16 v29, v86, v51
  v_dot2c_f32_bf16 v30, v87, v50
  v_dot2c_f32_bf16 v31, v87, v51
  v_dot2c_f32_bf16 v32, v88, v50
  v_dot2c_f32_bf16 v33, v88, v51
  v_dot2c_f32_bf16 v34, v89, v50
  v_dot2c_f32_bf16 v35, v89, v51
  v_dot2c_f32_bf16 v36, v90, v50
  v_dot2c_f32_bf16 v37, v90, v51
  v_dot2c_f32_bf16 v38, v91, v50
  v_dot2c_f32_bf16 v39, v91, v51
  v_dot2c_f32_bf16 v16, v92, v52
  v_dot2c_f32_bf16 v17, v92, v53
  v_dot2c_f32_bf16 v18, v93, v52
  v_dot2c_f32_bf16 v19, v93, v53
  v_dot2c_f32_bf16 v20, v94, v52
  v_dot2c_f32_bf16 v21, v94, v53
  v_dot2c_f32_bf16 v22, v95, v52
  v_dot2c_f32_bf16 v23, v95, v53
  v_dot2c_f32_bf16 v24, v96, v52
  v_dot2c_f32_bf16 v25, v96, v53
  v_dot2c_f32_bf16 v26, v97, v52
  v_dot2c_f32_bf16 v27, v97, v53
  v_dot2c_f32_bf16 v28, v98, v52
  v_dot2c_f32_bf16 v29, v98, v53
  v_dot2c_f32_bf16 v30, v99, v52
  v_dot2c_f32_bf16 v31, v99, v53
  v_dot2c_f32_bf16 v32, v100, v52
  v_dot2c_f32_bf16 v33, v100, v53
  v_dot2c_f32_bf16 v34, v101, v52
  v_dot2c_f32_bf16 v35, v101, v53
  v_dot2c_f32_bf16 v36, v102, v52
  v_dot2c_f32_bf16 v37, v102, v53
  v_dot2c_f32_bf16 v38, v103, v52
  v_dot2c_f32_bf16 v39, v103, v53
  s_nop 1
  s_branch L_loopd
.p2align 6
L_loope:
  s_waitcnt vmcnt(6)
  ds_read_b32 v3, v55
  v_mov_b32 v42, 0
  v_mov_b32 v43, 0
  v_dot2c_f32_bf16 v42, v56, v4
  v_dot2c_f32_bf16 v43, v68, v4
  v_dot2c_f32_bf16 v42, v57, v5
  v_dot2c_f32_bf16 v43, v69, v5
  v_dot2c_f32_bf16 v42, v58, v6
  v_dot2c_f32_bf16 v43, v70, v6
  v_dot2c_f32_bf16 v42, v59, v7
  v_dot2c_f32_bf16 v43, v71, v7
  v_dot2c_f32_bf16 v42, v60, v8
  v_dot2c_f32_bf16 v43, v72, v8
  v_dot2c_f32_bf16 v42, v61, v9
  v_dot2c_f32_bf16 v43, v73, v9
  v_dot2c_f32_bf16 v42, v62, v10
  v_dot2c_f32_bf16 v43, v74, v10
  v_dot2c_f32_bf16 v42, v63, v11
  v_dot2c_f32_bf16 v43, v75, v11
  v_dot2c_f32_bf16 v42, v64, v12
  v_dot2c_f32_bf16 v43, v76, v12
  v_dot2c_f32_bf16 v42, v65, v13
  v_dot2c_f32_bf16 v43, v77, v13
  v_dot2c_f32_bf16 v42, v66, v14
  v_dot2c_f32_bf16 v43, v78, v14
  v_dot2c_f32_bf16 v42, v67, v15
  v_dot2c_f32_bf16 v43, v79, v15
  s_nop 1
  v_add_f32_dpp v42, v42, v42 quad_perm:[1,0,3,2] row_mask:0xf bank_mask:0xf
  v_add_f32_dpp v43, v43, v43 quad_perm:[1,0,3,2] row_mask:0xf bank_mask:0xf
  s_nop 0
  v_add_f32_dpp v42, v42, v42 quad_perm:[2,3,0,1] row_mask:0xf bank_mask:0xf
  v_add_f32_dpp v43, v43, v43 quad_perm:[2,3,0,1] row_mask:0xf bank_mask:0xf
  s_nop 0
  v_add_f32_dpp v42, v42, v42 row_half_mirror row_mask:0xf bank_mask:0xf
  v_add_f32_dpp v43, v43, v43 row_half_mirror row_mask:0xf bank_mask:0xf
  v_cvt_pk_bf16_f32 v54, v42, v43
  v_lshlrev_b32 v42, 16, v54
  v_and_b32 v43, 0xffff0000, v54
  v_mul_f32 v42, s33, v42
  v_mul_f32 v43, s33, v43
  v_cvt_pk_bf16_f32 v54, v42, v43
  v_lshlrev_b32 v42, 16, v54
  v_and_b32 v43, 0xffff0000, v54
  v_mul_f32 v44, s34, v42
  v_mul_f32 v45, s34, v43
  v_max3_f32 v46, v40, v44, v45
  v_sub_f32 v48, v40, v46
  v_sub_f32 v44, v44, v46
  v_sub_f32 v45, v45, v46
  v_exp_f32 v48, v48
  v_exp_f32 v44, v44
  v_exp_f32 v45, v45
  v_mov_b32 v40, v46
  v_cvt_pk_bf16_f32 v54, v44, v45
  v_fma_f32 v41, v41, v48, v44
  v_and_b32 v50, 0xffff, v54
  v_lshlrev_b32 v51, 16, v54
  v_lshrrev_b32 v52, 16, v54
  v_and_b32 v53, 0xffff0000, v54
  v_add_f32 v41, v41, v45
  v_pk_mul_f32 v[16:17], v[16:17], v[48:49] op_sel_hi:[1,0]
  v_pk_mul_f32 v[18:19], v[18:19], v[48:49] op_sel_hi:[1,0]
  v_pk_mul_f32 v[20:21], v[20:21], v[48:49] op_sel_hi:[1,0]
  v_pk_mul_f32 v[22:23], v[22:23], v[48:49] op_sel_hi:[1,0]
  v_pk_mul_f32 v[24:25], v[24:25], v[48:49] op_sel_hi:[1,0]
  v_pk_mul_f32 v[26:27], v[26:27], v[48:49] op_sel_hi:[1,0]
  v_pk_mul_f32 v[28:29], v[28:29], v[48:49] op_sel_hi:[1,0]
  v_pk_mul_f32 v[30:31], v[30:31], v[48:49] op_sel_hi:[1,0]
  v_pk_mul_f32 v[32:33], v[32:33], v[48:49] op_sel_hi:[1,0]
  v_pk_mul_f32 v[34:35], v[34:35], v[48:49] op_sel_hi:[1,0]
  v_pk_mul_f32 v[36:37], v[36:37], v[48:49] op_sel_hi:[1,0]
  v_pk_mul_f32 v[38:39], v[38:39], v[48:49] op_sel_hi:[1,0]
  s_mov_b32 s45, 2097152
  s_nop 0
L_tke_wait:
  s_waitcnt vmcnt(0) lgkmcnt(0)
  v_readfirstlane_b32 s46, v3
  s_nop 0
  s_cmp_lg_u32 s46, -1
  s_nop 1
  s_cbranch_scc1 L_tke_got
  s_sub_u32 s45, s45, 1
  s_cmp_eq_u32 s45, 0
  s_cbranch_scc1 L_last_tile
  ds_read_b32 v3, v55
  s_branch L_tke_wait
L_tke_got:
  s_cmp_ge_u32 s46, 2048
  s_cbranch_scc1 L_last_tile
L_e_mid:
  s_add_u32 s46, s46, s3
  s_add_u32 s46, s46, s57
  s_and_b32 s46, s46, 1023
  s_mul_i32 s44, s46, 6144
  s_add_u32 s44, s44, 201326592
  buffer_load_dwordx4 v[56:59], v1, s[36:39], s44 offen offset:0 nt
  buffer_load_dwordx4 v[60:63], v1, s[36:39], s44 offen offset:128 nt
  buffer_load_dwordx4 v[64:67], v1, s[36:39], s44 offen offset:256 nt
  buffer_load_dwordx4 v[68:71], v1, s[36:39], s44 offen offset:3072 nt
  buffer_load_dwordx4 v[72:75], v1, s[36:39], s44 offen offset:3200 nt
  buffer_load_dwordx4 v[76:79], v1, s[36:39], s44 offen offset:3328 nt
  s_add_u32 s47, s47, 1
  s_add_u32 s46, s47, 1
  v_add_u32 v55, 4, v55
  s_mov_b64 exec, 1
  v_mov_b32 v3, s46
  ds_max_u32 v2, v3 offset:16448
  s_mov_b64 exec, -1
  v_dot2c_f32_bf16 v16, v80, v50
  v_dot2c_f32_bf16 v17, v80, v51
  v_dot2c_f32_bf16 v18, v81, v50
  v_dot2c_f32_bf16 v19, v81, v51
  v_dot2c_f32_bf16 v20, v82, v50
  v_dot2c_f32_bf16 v21, v82, v51
  v_dot2c_f32_bf16 v22, v83, v50
  v_dot2c_f32_bf16 v23, v83, v51
  v_dot2c_f32_bf16 v24, v84, v50
  v_dot2c_f32_bf16 v25, v84, v51
  v_dot2c_f32_bf16 v26, v85, v50
  v_dot2c_f32_bf16 v27, v85, v51
  v_dot2c_f32_bf16 v28, v86, v50
  v_dot2c_f32_bf16 v29, v86, v51
  v_dot2c_f32_bf16 v30, v87, v50
  v_dot2c_f32_bf16 v31, v87, v51
  v_dot2c_f32_bf16 v32, v88, v50
  v_dot2c_f32_bf16 v33, v88, v51
  v_dot2c_f32_bf16 v34, v89, v50
  v_dot2c_f32_bf16 v35, v89, v51
  v_dot2c_f32_bf16 v36, v90, v50
  v_dot2c_f32_bf16 v37, v90, v51
  v_dot2c_f32_bf16 v38, v91, v50
  v_dot2c_f32_bf16 v39, v91, v51
  v_dot2c_f32_bf16 v16, v92, v52
  v_dot2c_f32_bf16 v17, v92, v53
  v_dot2c_f32_bf16 v18, v93, v52
  v_dot2c_f32_bf16 v19, v93, v53
  v_dot2c_f32_bf16 v20, v94, v52
  v_dot2c_f32_bf16 v21, v94, v53
  v_dot2c_f32_bf16 v22, v95, v52
  v_dot2c_f32_bf16 v23, v95, v53
  v_dot2c_f32_bf16 v24, v96, v52
  v_dot2c_f32_bf16 v25, v96, v53
  v_dot2c_f32_bf16 v26, v97, v52
  v_dot2c_f32_bf16 v27, v97, v53
  v_dot2c_f32_bf16 v28, v98, v52
  v_dot2c_f32_bf16 v29, v98, v53
  v_dot2c_f32_bf16 v30, v99, v52
  v_dot2c_f32_bf16 v31, v99, v53
  v_dot2c_f32_bf16 v32, v100, v52
  v_dot2c_f32_bf16 v33, v100, v53
  v_dot2c_f32_bf16 v34, v101, v52
  v_dot2c_f32_bf16 v35, v101, v53
  v_dot2c_f32_bf16 v36, v102, v52
  v_dot2c_f32_bf16 v37, v102, v53
  v_dot2c_f32_bf16 v38, v103, v52
  v_dot2c_f32_bf16 v39, v103, v53
  buffer_load_dwordx4 v[80:83], v1, s[40:43], s44 offen offset:0 nt
  buffer_load_dwordx4 v[84:87], v1, s[40:43], s44 offen offset:128 nt
  buffer_load_dwordx4 v[88:91], v1, s[40:43], s44 offen offset:256 nt
  buffer_load_dwordx4 v[92:95], v1, s[40:43], s44 offen offset:3072 nt
  buffer_load_dwordx4 v[96:99], v1, s[40:43], s44 offen offset:3200 nt
  buffer_load_dwordx4 v[100:103], v1, s[40:43], s44 offen offset:3328 nt
  s_branch L_loope
L_last_tile:
  v_dot2c_f32_bf16 v16, v80, v50
  v_dot2c_f32_bf16 v17, v80, v51
  v_dot2c_f32_bf16 v18, v81, v50
  v_dot2c_f32_bf16 v19, v81, v51
  v_dot2c_f32_bf16 v20, v82, v50
  v_dot2c_f32_bf16 v21, v82, v51
  v_dot2c_f32_bf16 v22, v83, v50
  v_dot2c_f32_bf16 v23, v83, v51
  v_dot2c_f32_bf16 v24, v84, v50
  v_dot2c_f32_bf16 v25, v84, v51
  v_dot2c_f32_bf16 v26, v85, v50
  v_dot2c_f32_bf16 v27, v85, v51
  v_dot2c_f32_bf16 v28, v86, v50
  v_dot2c_f32_bf16 v29, v86, v51
  v_dot2c_f32_bf16 v30, v87, v50
  v_dot2c_f32_bf16 v31, v87, v51
  v_dot2c_f32_bf16 v32, v88, v50
  v_dot2c_f32_bf16 v33, v88, v51
  v_dot2c_f32_bf16 v34, v89, v50
  v_dot2c_f32_bf16 v35, v89, v51
  v_dot2c_f32_bf16 v36, v90, v50
  v_dot2c_f32_bf16 v37, v90, v51
  v_dot2c_f32_bf16 v38, v91, v50
  v_dot2c_f32_bf16 v39, v91, v51
  v_dot2c_f32_bf16 v16, v92, v52
  v_dot2c_f32_bf16 v17, v92, v53
  v_dot2c_f32_bf16 v18, v93, v52
  v_dot2c_f32_bf16 v19, v93, v53
  v_dot2c_f32_bf16 v20, v94, v52
  v_dot2c_f32_bf16 v21, v94, v53
  v_dot2c_f32_bf16 v22, v95, v52
  v_dot2c_f32_bf16 v23, v95, v53
  v_dot2c_f32_bf16 v24, v96, v52
  v_dot2c_f32_bf16 v25, v96, v53
  v_dot2c_f32_bf16 v26, v97, v52
  v_dot2c_f32_bf16 v27, v97, v53
  v_dot2c_f32_bf16 v28, v98, v52
  v_dot2c_f32_bf16 v29, v98, v53
  v_dot2c_f32_bf16 v30, v99, v52
  v_dot2c_f32_bf16 v31, v99, v53
  v_dot2c_f32_bf16 v32, v100, v52
  v_dot2c_f32_bf16 v33, v100, v53
  v_dot2c_f32_bf16 v34, v101, v52
  v_dot2c_f32_bf16 v35, v101, v53
  v_dot2c_f32_bf16 v36, v102, v52
  v_dot2c_f32_bf16 v37, v102, v53
  v_dot2c_f32_bf16 v38, v103, v52
  v_dot2c_f32_bf16 v39, v103, v53
  s_nop 2
L_tiles_done:
  v_max_f32_dpp v46, v40, v40 row_ror:8 row_mask:0xf bank_mask:0xf
  v_mov_b32 v54, v46
  s_nop 1
  v_permlane16_swap_b32 v46, v54
  v_max_f32 v46, v46, v54
  v_mov_b32 v54, v46
  s_nop 1
  v_permlane32_swap_b32 v46, v54
  v_max_f32 v46, v46, v54
  v_sub_f32 v48, v40, v46
  v_exp_f32 v48, v48
  v_and_b32 v2, 7, v0
  v_mul_u32_u24 v2, 96, v2
  v_lshrrev_b32 v3, 4, v0
  v_mul_u32_u24 v3, 24, v3
  v_pk_mul_f32 v[16:17], v[16:17], v[48:49] op_sel_hi:[1,0]
  v_pk_mul_f32 v[18:19], v[18:19], v[48:49] op_sel_hi:[1,0]
  v_pk_mul_f32 v[20:21], v[20:21], v[48:49] op_sel_hi:[1,0]
  v_pk_mul_f32 v[22:23], v[22:23], v[48:49] op_sel_hi:[1,0]
  v_pk_mul_f32 v[24:25], v[24:25], v[48:49] op_sel_hi:[1,0]
  v_pk_mul_f32 v[26:27], v[26:27], v[48:49] op_sel_hi:[1,0]
  v_pk_mul_f32 v[28:29], v[28:29], v[48:49] op_sel_hi:[1,0]
  v_pk_mul_f32 v[30:31], v[30:31], v[48:49] op_sel_hi:[1,0]
  v_pk_mul_f32 v[32:33], v[32:33], v[48:49] op_sel_hi:[1,0]
  v_pk_mul_f32 v[34:35], v[34:35], v[48:49] op_sel_hi:[1,0]
  v_pk_mul_f32 v[36:37], v[36:37], v[48:49] op_sel_hi:[1,0]
  v_pk_mul_f32 v[38:39], v[38:39], v[48:49] op_sel_hi:[1,0]
  v_mul_f32 v41, v41, v48
  v_add_u32 v2, v2, v3
  s_mul_i32 s46, s3, 784
  v_add_u32 v2, s46, v2
  v_permlane32_swap_b32 v16, v28
  v_permlane32_swap_b32 v17, v29
  v_permlane32_swap_b32 v18, v30
  v_permlane32_swap_b32 v19, v31
  v_permlane32_swap_b32 v20, v32
  v_permlane32_swap_b32 v21, v33
  v_permlane32_swap_b32 v22, v34
  v_permlane32_swap_b32 v23, v35
  v_permlane32_swap_b32 v24, v36
  v_permlane32_swap_b32 v25, v37
  v_permlane32_swap_b32 v26, v38
  v_permlane32_swap_b32 v27, v39
  v_add_f32 v16, v16, v28
  v_add_f32 v17, v17, v29
  v_add_f32 v18, v18, v30
  v_add_f32 v19, v19, v31
  v_add_f32 v20, v20, v32
  v_add_f32 v21, v21, v33
  v_add_f32 v22, v22, v34
  v_add_f32 v23, v23, v35
  v_add_f32 v24, v24, v36
  v_add_f32 v25, v25, v37
  v_add_f32 v26, v26, v38
  v_add_f32 v27, v27, v39
  v_permlane16_swap_b32 v16, v22
  v_permlane16_swap_b32 v17, v23
  v_permlane16_swap_b32 v18, v24
  v_permlane16_swap_b32 v19, v25
  v_permlane16_swap_b32 v20, v26
  v_permlane16_swap_b32 v21, v27
  v_add_f32 v16, v16, v22
  v_add_f32 v17, v17, v23
  v_add_f32 v18, v18, v24
  v_add_f32 v19, v19, v25
  v_add_f32 v20, v20, v26
  v_add_f32 v21, v21, v27
  v_add_f32_dpp v16, v16, v16 row_ror:8 row_mask:0xf bank_mask:0xf
  v_add_f32_dpp v17, v17, v17 row_ror:8 row_mask:0xf bank_mask:0xf
  v_add_f32_dpp v18, v18, v18 row_ror:8 row_mask:0xf bank_mask:0xf
  v_add_f32_dpp v19, v19, v19 row_ror:8 row_mask:0xf bank_mask:0xf
  v_add_f32_dpp v20, v20, v20 row_ror:8 row_mask:0xf bank_mask:0xf
  v_add_f32_dpp v21, v21, v21 row_ror:8 row_mask:0xf bank_mask:0xf
  v_add_f32_dpp v41, v41, v41 row_ror:8 row_mask:0xf bank_mask:0xf
  v_mov_b32 v54, v41
  s_nop 1
  v_permlane16_swap_b32 v41, v54
  v_add_f32 v41, v41, v54
  v_mov_b32 v54, v41
  s_nop 1
  v_permlane32_swap_b32 v41, v54
  v_add_f32 v41, v41, v54
  ds_write_b64 v2, v[16:17] offset:8960
  ds_write_b64 v2, v[18:19] offset:8968
  ds_write_b64 v2, v[20:21] offset:8976
  v_mov_b32 v44, v46
  v_mov_b32 v45, v41
  v_mov_b32 v2, s46
  ds_write_b64 v2, v[44:45] offset:9728
  s_waitcnt lgkmcnt(0)
  v_mov_b32 v2, 0
  v_mov_b32 v3, 1
  s_mov_b64 exec, 1
  ds_add_u32 v2, v3 offset:15888
  s_mov_b64 exec, -1
  s_waitcnt lgkmcnt(0)
  s_endpgm
L_end:
  s_endpgm

.section .rodata,"a"
.p2align 6
.amdhsa_kernel recurrent_scan__mha_block_cached__swiglu_ffn__decode_kernel
  .amdhsa_next_free_vgpr 256
  .amdhsa_next_free_sgpr 102
  .amdhsa_accum_offset 256
  .amdhsa_group_segment_fixed_size 0
  .amdhsa_kernarg_size 96
  .amdhsa_user_sgpr_count 2
  .amdhsa_user_sgpr_kernarg_segment_ptr 1
  .amdhsa_system_sgpr_workgroup_id_x 1
.end_amdhsa_kernel
```
